```python
import torch

def _softmax(x, axis=-1):
    return torch.softmax(x, dim=axis)
def _gelu(x):
    return torch.nn.functional.gelu(x, approximate="tanh")
def _silu(x):
    return torch.nn.functional.silu(x)
def _sigmoid(x):
    return torch.sigmoid(x)
def _layernorm(x, axis=-1, eps=1e-5):
    m = x.mean(dim=axis, keepdim=True)
    v = x.var(dim=axis, keepdim=True, unbiased=False)
    return (x - m) / torch.sqrt(v + eps)
def _scatter_add(tgt, idx, src, axis=0):
    return tgt.clone().index_add_(axis, idx, src)
def _segment_sum(src, seg, n):
    out = torch.zeros((n,) + src.shape[1:], dtype=src.dtype)
    return out.index_add_(0, seg, src)
def _pad(x, pw):
    flat = tuple(v for pair in reversed(pw) for v in pair)
    return torch.nn.functional.pad(x, flat)

kernel_name = 'gated_mix__ssm_conv_s5__dense_activation_gelu__prompt'

def setup_inputs():

    _w = (lambda a: (lambda t: t.to(torch.bfloat16) if t.is_floating_point() else t)(torch.as_tensor(a)))
    def _A_setup():
        B, S, D = 1, 2048, 448
        P = D
        Lambda_re = -0.5 * (lambda _x: torch.exp(torch.as_tensor(_x)))((lambda *s: torch.randn(*s, dtype=torch.bfloat16) * 0.2)(P))
        Lambda_im = (lambda *s: torch.randn(*s, dtype=torch.bfloat16) * 0.8)(P) * 1.0
        B_re = (lambda *s: torch.randn(*s, dtype=torch.bfloat16) * 0.2)(P, D) * (D ** -0.5)
        B_im = (lambda *s: torch.randn(*s, dtype=torch.bfloat16) * 0.2)(P, D) * (D ** -0.5)
        C_re = (lambda *s: torch.randn(*s, dtype=torch.bfloat16) * 0.2)(D, P) * (P ** -0.5)
        C_im = (lambda *s: torch.randn(*s, dtype=torch.bfloat16) * 0.2)(D, P) * (P ** -0.5)
        log_dt = (lambda *s: torch.randn(*s, dtype=torch.bfloat16) * 0.2)(P) * 0.3 - 2.0
        Dskip = (lambda *s: torch.randn(*s, dtype=torch.bfloat16) * 0.05)(D)
        return {
            "x": _w((lambda *s: torch.randn(*s, dtype=torch.bfloat16) * 0.05)(B, S, D)),
            "Lambda_re": _w(Lambda_re),
            "Lambda_im": _w(Lambda_im),
            "B_re": _w(B_re),
            "B_im": _w(B_im),
            "C_re": _w(C_re),
            "C_im": _w(C_im),
            "log_dt": _w(log_dt),
            "Dskip": _w(Dskip),
        }
    _A_in = _A_setup()

    def _B_setup():
        B, S, D, F = 1, 2048, 448, 1792
        return {
            "x": _w((lambda *s: torch.randn(*s, dtype=torch.bfloat16) * 0.05)(B, S, D)),
            "w1": _w((lambda *s: torch.randn(*s, dtype=torch.bfloat16) * 3.2)(D, F) * (D ** -0.5)),
            "b1": _w((lambda *s: torch.randn(*s, dtype=torch.bfloat16) * 3.2)(F) * 0.01),
            "w2": _w((lambda *s: torch.randn(*s, dtype=torch.bfloat16) * 0.1)(F, D) * (F ** -0.5)),
            "b2": _w((lambda *s: torch.randn(*s, dtype=torch.bfloat16) * 0.2)(D) * 0.01),
        }
    _B_in = _B_setup()

    return {
        "A_x": _A_in["x"],
        "A_Lambda_re": _A_in["Lambda_re"],
        "A_Lambda_im": _A_in["Lambda_im"],
        "A_B_re": _A_in["B_re"],
        "A_B_im": _A_in["B_im"],
        "A_C_re": _A_in["C_re"],
        "A_C_im": _A_in["C_im"],
        "A_log_dt": _A_in["log_dt"],
        "A_Dskip": _A_in["Dskip"],
        "B_x": _B_in["x"],
        "B_w1": _B_in["w1"],
        "B_b1": _B_in["b1"],
        "B_w2": _B_in["w2"],
        "B_b2": _B_in["b2"],
        "gate_w": _w((lambda *s: torch.randn(*s, dtype=torch.bfloat16) * 0.05)(448) * 16.0),
    }

def reference(A_x, A_Lambda_re, A_Lambda_im, A_B_re, A_B_im, A_C_re, A_C_im, A_log_dt, A_Dskip, B_x, B_w1, B_b1, B_w2, B_b2, gate_w):
    def _A_ref(x, Lambda_re, Lambda_im, B_re, B_im, C_re, C_im, log_dt, Dskip):
        Bsz, L, H = x.shape
        Lam = Lambda_re + 1j * Lambda_im
        Bmat = B_re + 1j * B_im
        Cmat = C_re + 1j * C_im
        dt = torch.exp(log_dt)
        Lam_bar = torch.exp(dt * Lam)
        B_bar = ((Lam_bar - 1.0) / Lam)[:, None] * Bmat
        Bu = torch.einsum("bld,pd->blp", x + 0j, B_bar)
        h = torch.zeros_like(Bu[:, 0, :])
        hs = []
        for t in range(L):
            h = Lam_bar[None, :] * h + Bu[:, t, :]
            hs.append(h)
        hseq = torch.stack(hs, 1)
        y = 2.0 * torch.einsum("blp,dp->bld", hseq, Cmat).real + x * Dskip[None, None, :]
        return y

    def _B_ref(x, w1, b1, w2, b2):
        h = torch.einsum("bsd,df->bsf", x, w1) + b1
        h = _gelu(h)
        return torch.einsum("bsf,fd->bsd", h, w2) + b2

    x = A_x
    g = _sigmoid((x * gate_w).sum(-1, keepdims=True))
    a = _A_ref(x, A_Lambda_re, A_Lambda_im, A_B_re, A_B_im, A_C_re, A_C_im, A_log_dt, A_Dskip)
    b = _B_ref(x, B_w1, B_b1, B_w2, B_b2)
    return g * a + (1 - g) * b
```

```asm
; @launch grid=(256,1,1) block=(256,1,1) lds=161792
.amdgcn_target "amdgcn-amd-amdhsa--gfx950"
.text
.globl gated_mix__ssm_conv_s5__dense_activation_gelu__prompt_kernel
.p2align 8
.type gated_mix__ssm_conv_s5__dense_activation_gelu__prompt_kernel,@function
gated_mix__ssm_conv_s5__dense_activation_gelu__prompt_kernel:
    s_load_dwordx16 s[4:19], s[0:1], 0
    s_load_dwordx16 s[20:35], s[0:1], 64
    s_load_dwordx2 s[36:37], s[0:1], 136
    s_cmp_ge_u32 s2, 256
    s_cbranch_scc1 L_exit
    s_getpc_b64 s[52:53]
    s_and_b32 s52, s52, 0xffffff00
    v_lshrrev_b32 v241, 4, v0
    s_lshr_b32 s95, s2, 3
    v_lshl_add_u32 v241, s95, 4, v241
    v_lshlrev_b32 v241, 7, v241
    v_and_b32 v241, 0x7f80, v241
    v_min_u32 v241, L_end-gated_mix__ssm_conv_s5__dense_activation_gelu__prompt_kernel-4, v241
    global_load_dword v254, v241, s[52:53]
    v_lshrrev_b32 v59, 6, v0
    v_and_b32 v1, 63, v0
    s_lshr_b32 s83, s2, 3
    s_and_b32 s84, s2, 1
    v_readfirstlane_b32 s76, v59
    s_cmp_ge_u32 s83, 28
    s_cbranch_scc1 L_helper
    s_lshl_b32 s84, s84, 2
    s_lshr_b32 s78, s2, 1
    s_and_b32 s78, s78, 2
    s_xor_b32 s78, s78, s2
    s_and_b32 s78, s78, 6
    s_lshl_b32 s78, s78, 2
    s_and_b32 s89, s83, 7
    s_add_u32 s78, s78, s89
    s_lshr_b32 s77, s83, 3
    s_add_u32 s77, s77, s84
    s_cmp_ge_u32 s83, 24
    s_cselect_b32 s77, 3, s77
    s_cselect_b32 s84, s84, 0
    s_add_u32 s78, s78, s84
    v_lshrrev_b32 v59, 3, v1
    v_lshrrev_b32 v60, 4, v1
    v_and_b32 v61, 7, v1
    v_mul_u32_u24 v62, 896, v59
    v_xor_b32 v63, v61, v60
    v_lshl_add_u32 v2, v63, 4, v62
    v_xor_b32 v4, 64, v2
    v_add_u32 v3, 6144, v4
    s_lshl_b32 s80, s78, 2
    s_add_u32 s80, s80, s76
    s_mul_i32 s80, s80, 14336
    s_lshl_b32 s88, s76, 11
    s_add_u32 s88, s88, 98304
    s_lshl_b32 s91, s77, 1
    s_add_u32 s91, s91, s78
    s_mul_i32 s83, s91, 37
    s_lshr_b32 s83, s83, 8
    s_mul_i32 s83, s83, 7
    s_sub_u32 s91, s91, s83
    s_lshl_b32 s3, s91, 7
    s_mov_b32 s42, 1835008
    s_mov_b32 s43, 0x20000
    v_add_u32 v5, 5120, v2
    v_add_u32 v6, 5120, v4
    s_mul_i32 s79, s76, 24576
    s_lshl_b32 s89, s77, 2
    s_add_u32 s89, s89, s76
    s_mul_i32 s81, s89, 14336
    s_mov_b32 s46, 401408
    s_mov_b32 s47, 0x20000
    s_mov_b32 s50, 402432
    s_mov_b32 s51, 0x20000
    s_add_u32 s38, s3, 128
    s_cmp_eq_u32 s38, 896
    s_cselect_b32 s38, 0, s38
    s_waitcnt lgkmcnt(0)
    s_mov_b64 s[40:41], s[4:5]
    s_add_u32 m0, s88, 0
    s_add_u32 s83, s80, s3
    buffer_load_dwordx4 v2, s[40:43], s83 offen lds
    buffer_load_dwordx4 v3, s[40:43], s83 offen offset:1024 lds
    s_mov_b64 s[44:45], s[10:11]
    s_sub_u32 s48, s12, 1024
    s_subb_u32 s49, s13, 0
    s_add_u32 m0, s79, 0
    s_add_u32 s83, s81, s3
    buffer_load_dwordx4 v2, s[44:47], s83 offen offset:0 lds
    buffer_load_dwordx4 v4, s[48:51], s83 offen offset:1024 lds
    buffer_load_dwordx4 v5, s[44:47], s83 offen offset:2048 lds
    buffer_load_dwordx4 v6, s[48:51], s83 offen offset:3072 lds
    s_add_u32 m0, s88, 8192
    s_add_u32 s83, s80, s38
    buffer_load_dwordx4 v2, s[40:43], s83 offen lds
    buffer_load_dwordx4 v3, s[40:43], s83 offen offset:1024 lds
    s_add_u32 s39, s38, 128
    s_cmp_eq_u32 s39, 896
    s_cselect_b32 s39, 0, s39
    s_add_u32 s96, s39, 128
    s_cmp_eq_u32 s96, 896
    s_cselect_b32 s96, 0, s96
    s_add_u32 s97, s96, 128
    s_cmp_eq_u32 s97, 896
    s_cselect_b32 s97, 0, s97
    s_add_u32 s22, s97, 128
    s_cmp_eq_u32 s22, 896
    s_cselect_b32 s22, 0, s22
    s_add_u32 s23, s22, 128
    s_cmp_eq_u32 s23, 896
    s_cselect_b32 s23, 0, s23
    v_and_b32 v241, 31, v1
    v_lshrrev_b32 v242, 5, v1
    v_lshrrev_b32 v62, 4, v241
    v_and_b32 v63, 7, v241
    v_lshl_add_u32 v62, v62, 3, v63
    s_lshl_b32 s83, s89, 4
    v_add_lshl_u32 v62, v62, s83, 1
    v_mov_b32 v63, 0
    v_lshlrev_b32 v41, 4, v1
    s_lshl_b32 s83, s76, 7
    v_add_u32 v194, s83, v41
    v_subrev_u32 v195, 896, v194
    v_min_u32 v194, v194, v195
    s_movk_i32 s83, 127
    s_cmp_eq_u32 s76, 2
    s_cselect_b32 s83, 511, s83
    s_cselect_b32 s95, 9, 7
    s_cselect_b64 s[30:31], s[26:27], s[30:31]
    s_lshl_b32 s95, s77, s95
    v_and_b32 v195, s83, v41
    v_add_u32 v195, s95, v195
    s_cmp_lt_u32 s76, 2
    s_cselect_b64 vcc, -1, 0
    s_cselect_b64 s[30:31], s[32:33], s[30:31]
    v_cndmask_b32 v194, v195, v194, vcc
    s_cmp_eq_u32 s76, 3
    s_cselect_b64 vcc, 0xff, 0
    v_mov_b32 v192, s30
    v_mov_b32 v193, s31
    v_mov_b32 v196, s20
    v_mov_b32 v197, s21
    v_cndmask_b32 v192, v192, v196, vcc
    v_cndmask_b32 v193, v193, v197, vcc
    v_add_co_u32 v192, vcc, v192, v194
    s_lshl_b32 s83, s76, 10
    s_add_u32 m0, s83, 157696
    v_addc_co_u32 v193, vcc, 0, v193, vcc
    s_sub_u32 s52, s24, 4096
    s_subb_u32 s53, s25, 0
    s_mov_b32 s54, 1609728
    s_mov_b32 s55, 0x20000
    s_mov_b32 s56, s28
    s_mov_b32 s57, s29
    s_mov_b32 s58, 1605632
    s_mov_b32 s59, 0x20000
    s_mov_b32 s72, s34
    s_mov_b32 s73, s35
    s_mov_b32 s74, 3670016
    s_mov_b32 s75, 0x20000
    s_cmp_ge_u32 s76, 2
    s_cselect_b32 s60, s16, s14
    s_cselect_b32 s61, s17, s15
    s_mov_b32 s62, 401408
    s_mov_b32 s63, 0x20000
    s_lshl_b32 s83, s89, 12
    s_add_u32 s83, s83, 4096
    s_add_u32 s64, s36, s83
    s_addc_u32 s65, s37, 0
    s_mov_b32 s66, 4096
    s_mov_b32 s67, 0x20000
    s_mul_i32 s83, s78, 401408
    s_add_u32 s83, s83, 1048576
    s_add_u32 s68, s36, s83
    s_addc_u32 s69, s37, 0
    s_mov_b32 s70, 401408
    s_mov_b32 s71, 0x20000
    s_lshl_b32 s82, s89, 7
    s_cmp_ge_u32 s76, 2
    s_cselect_b32 s83, 114688, 0
    s_add_u32 s82, s82, s83
    s_lshl_b32 s83, s83, 1
    s_sub_u32 s85, 114688, s83
    s_lshl_b32 s86, s77, 3
    s_add_u32 s86, s86, s76
    s_mul_i32 s86, s86, 28672
    s_and_b32 s95, s76, 1
    s_mul_i32 s87, s95, 28672
    s_lshl_b32 s83, s77, 7
    s_add_u32 s87, s87, s83
    s_bfe_u32 s83, s78, 0x10002
    s_mul_i32 s83, s83, 7
    s_add_u32 s83, s83, s77
    s_mov_b32 s0, 48482
    s_mov_b32 s1, 105637
    s_cmp_eq_u32 s83, 1
    s_cselect_b32 s0, 68382, s0
    s_cselect_b32 s1, 10030, s1
    s_cmp_eq_u32 s83, 2
    s_cselect_b32 s0, 104501, s0
    s_cselect_b32 s1, 47472, s1
    s_cmp_eq_u32 s83, 3
    s_cselect_b32 s0, 9132, s0
    s_cselect_b32 s1, 68492, s1
    s_cmp_eq_u32 s83, 4
    s_cselect_b32 s0, 189507, s0
    s_cselect_b32 s1, 218179, s1
    s_cmp_eq_u32 s83, 5
    s_cselect_b32 s0, 214664, s0
    s_cselect_b32 s1, 156186, s1
    s_cmp_eq_u32 s83, 6
    s_cselect_b32 s0, 151761, s0
    s_cselect_b32 s1, 180433, s1
    s_cmp_eq_u32 s83, 7
    s_cselect_b32 s0, 44387, s0
    s_cselect_b32 s1, 73059, s1
    s_cmp_eq_u32 s83, 8
    s_cselect_b32 s0, 67500, s0
    s_cselect_b32 s1, 11038, s1
    s_cmp_eq_u32 s83, 9
    s_cselect_b32 s0, 6389, s0
    s_cselect_b32 s1, 35061, s1
    s_cmp_eq_u32 s83, 10
    s_cselect_b32 s0, 158344, s0
    s_cselect_b32 s1, 213672, s1
    s_cmp_eq_u32 s83, 11
    s_cselect_b32 s0, 177222, s0
    s_cselect_b32 s1, 120193, s1
    s_cmp_eq_u32 s83, 12
    s_cselect_b32 s0, 213530, s0
    s_cselect_b32 s1, 157194, s1
    s_cmp_eq_u32 s83, 13
    s_cselect_b32 s0, 119057, s0
    s_cselect_b32 s1, 176212, s1
    s_mov_b32 s92, 0x3f80
    s_mov_b32 s93, 0x3f800000
    s_mov_b32 s94, 262144
    v_add_u32 v7, 12288, v2
    v_add_u32 v8, 18432, v4
    v_and_b32 v246, 3, v59
    v_and_b32 v247, 2, v59
    v_lshlrev_b32 v247, 1, v247
    v_xor_b32 v246, v246, v247
    v_xor_b32 v246, v246, v61
    v_lshlrev_b32 v246, 4, v246
    v_mul_u32_u24 v247, 3584, v59
    v_add_u32 v9, v247, v246
    v_mul_u32_u24 v247, 896, v59
    v_add_u32 v13, v247, v246
    s_mul_i32 s83, s95, 57344
    s_sub_u32 s92, 59392, s83
    s_add_u32 s83, s83, 4096
    v_add_u32 v11, s92, v9
    v_add_u32 v9, s83, v9
    v_add_u32 v10, 27648, v9
    v_add_u32 v12, 27648, v11
    v_add_u32 v14, 6144, v13
    v_add_u32 v15, 12288, v13
    v_add_u32 v16, 18432, v13
    v_bfe_u32 v246, v241, 2, 1
    v_lshrrev_b32 v247, 3, v241
    v_and_b32 v243, 3, v241
    v_lshl_add_u32 v243, v246, 4, v243
    v_lshl_add_u32 v243, v247, 2, v243
    v_bfe_u32 v244, v243, 1, 3
    v_xor_b32 v246, v242, v244
    v_lshlrev_b32 v246, 4, v246
    v_lshl_add_u32 v246, v243, 7, v246
    s_lshl_b32 s92, s76, 5
    v_xor_b32 v246, s92, v246
    v_add_u32 v17, 98304, v246
    v_xor_b32 v18, 32, v17
    v_xor_b32 v19, 64, v17
    v_xor_b32 v20, 96, v17
    v_bfe_u32 v246, v241, 1, 3
    v_xor_b32 v246, v242, v246
    v_lshlrev_b32 v246, 4, v246
    v_lshl_add_u32 v246, v241, 7, v246
    v_xor_b32 v246, s92, v246
    v_add_u32 v21, s79, v246
    v_xor_b32 v22, 32, v21
    v_xor_b32 v23, 64, v21
    v_xor_b32 v24, 96, v21
    v_lshlrev_b32 v246, 4, v244
    v_lshl_add_u32 v246, v243, 7, v246
    v_mul_u32_u24 v247, 49152, v242
    s_mul_i32 s83, s95, 24576
    v_add3_u32 v29, v246, v247, s83
    v_xor_b32 v30, 16, v29
    v_xor_b32 v31, 32, v29
    v_xor_b32 v32, 48, v29
    v_xor_b32 v33, 64, v29
    v_xor_b32 v34, 80, v29
    v_xor_b32 v35, 96, v29
    v_xor_b32 v36, 112, v29
    v_bfe_u32 v245, v1, 2, 2
    v_and_b32 v246, 2, v245
    v_lshlrev_b32 v246, 1, v246
    v_xor_b32 v246, v246, v245
    v_and_b32 v247, 1, v1
    v_bfe_u32 v248, v1, 4, 1
    v_lshl_add_u32 v247, v247, 1, v248
    v_xor_b32 v246, v246, v247
    v_lshlrev_b32 v246, 4, v246
    v_lshl_add_u32 v246, v245, 7, v246
    v_bfe_u32 v247, v1, 1, 1
    v_lshl_add_u32 v246, v247, 3, v246
    v_lshl_add_u32 v247, v242, 10, v246
    v_add_u32 v25, s79, v247
    v_xor_b32 v26, 64, v25
    s_lshr_b32 s84, s76, 1
    s_lshl_b32 s83, s84, 6
    v_xor_b32 v247, s83, v247
    v_add_u32 v37, 131072, v247
    s_lshl_b32 s83, s95, 6
    v_lshl_add_u32 v247, v242, 11, v246
    v_xor_b32 v27, s83, v247
    v_add_u32 v28, 49152, v27
    s_lshl_b32 s83, s76, 13
    s_add_u32 s83, s83, 98304
    v_add_u32 v38, s83, v41
    s_lshl_b32 s83, s84, 10
    s_add_u32 s83, s83, 98304
    v_add_u32 v39, s83, v41
    v_and_b32 v246, 3, v241
    v_and_b32 v247, 2, v241
    v_lshlrev_b32 v247, 1, v247
    v_xor_b32 v246, v246, v247
    v_lshlrev_b32 v247, 1, v242
    v_xor_b32 v246, v246, v247
    v_lshlrev_b32 v246, 4, v246
    v_lshl_add_u32 v246, v241, 7, v246
    s_lshl_b32 s83, s76, 12
    s_add_u32 s83, s83, 131072
    v_add_u32 v40, s83, v246
    s_sub_u32 s83, 32, s78
    s_lshl_b32 s83, s83, 7
    v_add_u32 v42, s83, v41
    s_sub_u32 s83, s83, 128
    v_lshl_add_u32 v247, v241, 2, s83
    v_lshl_add_u32 v44, v242, 16, v247
    s_lshl_b32 s34, s76, 12
    s_add_u32 s34, s34, 131072
    v_lshl_add_u32 v43, v1, 2, s34
    v_lshl_add_u32 v246, v242, 5, v243
    s_lshl_b32 s83, s76, 2
    s_add_u32 s83, s83, 155648
    v_lshl_add_u32 v45, v246, 4, s83
    v_lshlrev_b32 v247, 4, v243
    v_add_u32 v46, 155648, v247
    s_lshl_b32 s83, s76, 8
    s_add_u32 s83, s83, 156672
    v_lshl_add_u32 v47, v246, 2, s83
    v_lshl_add_u32 v48, v242, 6, s83
    s_sub_u32 s83, s77, s91
    s_cselect_b32 s92, 7, 0
    s_add_u32 s83, s83, s92
    s_lshl_b32 s83, s83, 1
    s_add_u32 s83, s83, s84
    s_lshl_b32 s83, s83, 12
    s_add_u32 s83, s83, 98304
    s_lshl_b32 s92, s95, 2
    v_lshl_add_u32 v246, v242, 1, s92
    v_xor_b32 v246, v246, v244
    v_lshlrev_b32 v246, 4, v246
    v_lshl_add_u32 v246, v243, 7, v246
    v_add_u32 v50, s83, v246
    s_lshl_b32 s83, s95, 6
    s_add_u32 s83, s83, 160768
    v_lshl_add_u32 v51, v242, 5, s83
    s_lshl_b32 s83, s78, 1
    s_add_u32 s83, s83, s84
    s_mul_i32 s83, s83, 57344
    s_lshl_b32 s92, s77, 1
    s_add_u32 s92, s92, s95
    s_lshl_b32 s92, s92, 7
    s_add_u32 s83, s83, s92
    v_mul_u32_u24 v246, 1792, v59
    v_lshl_add_u32 v246, v61, 4, v246
    v_add_u32 v49, s83, v246
    v_and_b32 v246, 7, v241
    v_lshlrev_b32 v247, 2, v242
    v_xor_b32 v246, v246, v247
    v_lshlrev_b32 v246, 4, v246
    s_lshl_b32 s83, s76, 12
    s_add_u32 s83, s83, 98304
    v_lshl_add_u32 v246, v243, 7, v246
    v_add_u32 v253, s83, v246
    v_and_b32 v246, 3, v59
    v_lshlrev_b32 v246, 4, v246
    v_xor_b32 v246, v246, v41
    v_add_u32 v0, s83, v246
    s_mul_i32 s83, s76, 32
    s_add_u32 s83, s83, s3
    s_add_u32 s83, s83, 157696
    v_lshl_add_u32 v250, v242, 4, s83
    s_lshl_b32 s83, s76, 7
    s_add_u32 s83, s83, 159744
    v_lshl_add_u32 v251, v242, 5, s83
    s_mov_b32 s92, 0x3f80
    v_mov_b32 v52, 0xbdd2d3e8
    v_mov_b32 v53, 0xc0135761
    global_load_lds_dwordx4 v[192:193], off
    global_load_ushort v208, v62, s[18:19]
    global_load_ushort v209, v62, s[6:7]
    global_load_ushort v210, v62, s[8:9]
    global_load_dword v211, v63, s[36:37] sc1
    s_add_u32 m0, s79, 4096
    s_add_u32 s83, s81, s38
    buffer_load_dwordx4 v2, s[44:47], s83 offen offset:0 lds
    buffer_load_dwordx4 v4, s[48:51], s83 offen offset:1024 lds
    buffer_load_dwordx4 v5, s[44:47], s83 offen offset:2048 lds
    buffer_load_dwordx4 v6, s[48:51], s83 offen offset:3072 lds
    s_add_u32 m0, s88, 16384
    s_add_u32 s83, s80, s39
    buffer_load_dwordx4 v2, s[40:43], s83 offen lds
    buffer_load_dwordx4 v3, s[40:43], s83 offen offset:1024 lds
    s_add_u32 m0, s79, 8192
    s_add_u32 s83, s81, s39
    buffer_load_dwordx4 v2, s[44:47], s83 offen offset:0 lds
    buffer_load_dwordx4 v4, s[48:51], s83 offen offset:1024 lds
    buffer_load_dwordx4 v5, s[44:47], s83 offen offset:2048 lds
    buffer_load_dwordx4 v6, s[48:51], s83 offen offset:3072 lds
    s_waitcnt vmcnt(17)
    s_barrier
    ds_read_b128 v[160:163], v21 offset:0
    ds_read_b128 v[164:167], v22 offset:0
    ds_read_b128 v[168:171], v23 offset:0
    ds_read_b128 v[172:175], v24 offset:0
    ds_read_b128 a[0:3], v17 offset:0
    ds_read_b128 a[4:7], v17 offset:4096
    ds_read_b128 a[8:11], v18 offset:0
    ds_read_b128 a[12:15], v18 offset:4096
    ds_read_b128 a[16:19], v19 offset:0
    ds_read_b128 a[20:23], v19 offset:4096
    ds_read_b128 a[24:27], v20 offset:0
    ds_read_b128 a[28:31], v20 offset:4096
    s_waitcnt lgkmcnt(7)
    v_mfma_f32_32x32x16_bf16 v[64:79], a[0:3], v[160:163], 0
    s_waitcnt vmcnt(6)
    s_barrier
    ds_read_b128 v[176:179], v21 offset:4096
    ds_read_b128 v[180:183], v22 offset:4096
    s_waitcnt lgkmcnt(8)
    v_mfma_f32_32x32x16_bf16 v[80:95], a[4:7], v[160:163], 0
    ds_read_b128 v[184:187], v23 offset:4096
    ds_read_b128 v[188:191], v24 offset:4096
    s_add_u32 m0, s88, 24576
    s_add_u32 s83, s80, s96
    buffer_load_dwordx4 v2, s[40:43], s83 offen lds
    s_waitcnt lgkmcnt(4)
    v_mfma_f32_32x32x16_bf16 v[64:79], a[8:11], v[164:167], v[64:79]
    ds_read_b128 a[32:35], v17 offset:8192
    ds_read_b128 a[36:39], v17 offset:12288
    buffer_load_dwordx4 v3, s[40:43], s83 offen offset:1024 lds
    v_mfma_f32_32x32x16_bf16 v[80:95], a[12:15], v[164:167], v[80:95]
    ds_read_b128 a[40:43], v18 offset:8192
    ds_read_b128 a[44:47], v18 offset:12288
    s_add_u32 m0, s79, 12288
    s_add_u32 s83, s81, s96
    buffer_load_dwordx4 v2, s[44:47], s83 offen offset:0 lds
    v_mfma_f32_32x32x16_bf16 v[64:79], a[16:19], v[168:171], v[64:79]
    ds_read_b128 a[48:51], v19 offset:8192
    ds_read_b128 a[52:55], v19 offset:12288
    buffer_load_dwordx4 v4, s[48:51], s83 offen offset:1024 lds
    v_mfma_f32_32x32x16_bf16 v[80:95], a[20:23], v[168:171], v[80:95]
    ds_read_b128 a[56:59], v20 offset:8192
    ds_read_b128 a[60:63], v20 offset:12288
    buffer_load_dwordx4 v5, s[44:47], s83 offen offset:2048 lds
    v_mfma_f32_32x32x16_bf16 v[64:79], a[24:27], v[172:175], v[64:79]
    buffer_load_dwordx4 v6, s[48:51], s83 offen offset:3072 lds
    v_mfma_f32_32x32x16_bf16 v[80:95], a[28:31], v[172:175], v[80:95]
    s_waitcnt lgkmcnt(0)
    v_mfma_f32_32x32x16_bf16 v[64:79], a[32:35], v[176:179], v[64:79]
    s_waitcnt vmcnt(6)
    s_barrier
    ds_read_b128 v[160:163], v21 offset:8192
    ds_read_b128 v[164:167], v22 offset:8192
    v_mfma_f32_32x32x16_bf16 v[80:95], a[36:39], v[176:179], v[80:95]
    ds_read_b128 v[168:171], v23 offset:8192
    ds_read_b128 v[172:175], v24 offset:8192
    s_add_u32 m0, s88, 32768
    s_add_u32 s83, s80, s97
    buffer_load_dwordx4 v2, s[40:43], s83 offen lds
    v_mfma_f32_32x32x16_bf16 v[64:79], a[40:43], v[180:183], v[64:79]
    ds_read_b128 a[64:67], v17 offset:16384
    ds_read_b128 a[68:71], v17 offset:20480
    buffer_load_dwordx4 v3, s[40:43], s83 offen offset:1024 lds
    v_mfma_f32_32x32x16_bf16 v[80:95], a[44:47], v[180:183], v[80:95]
    ds_read_b128 a[72:75], v18 offset:16384
    ds_read_b128 a[76:79], v18 offset:20480
    s_add_u32 m0, s79, 16384
    s_add_u32 s83, s81, s97
    buffer_load_dwordx4 v2, s[44:47], s83 offen offset:0 lds
    v_mfma_f32_32x32x16_bf16 v[64:79], a[48:51], v[184:187], v[64:79]
    ds_read_b128 a[80:83], v19 offset:16384
    ds_read_b128 a[84:87], v19 offset:20480
    buffer_load_dwordx4 v4, s[48:51], s83 offen offset:1024 lds
    v_lshlrev_b32 v208, 16, v208
    v_lshlrev_b32 v209, 16, v209
    v_mfma_f32_32x32x16_bf16 v[80:95], a[52:55], v[184:187], v[80:95]
    ds_read_b128 a[88:91], v20 offset:16384
    ds_read_b128 a[92:95], v20 offset:20480
    buffer_load_dwordx4 v5, s[44:47], s83 offen offset:2048 lds
    v_lshlrev_b32 v210, 16, v210
    v_readfirstlane_b32 s90, v211
    v_mfma_f32_32x32x16_bf16 v[64:79], a[56:59], v[188:191], v[64:79]
    ds_read_b128 v[112:115], v250 offset:0
    ds_read_b128 v[116:119], v250 offset:128
    buffer_load_dwordx4 v6, s[48:51], s83 offen offset:3072 lds
    v_mul_f32 v208, 0x3fb8aa3b, v208
    v_exp_f32 v208, v208
    v_mfma_f32_32x32x16_bf16 v[80:95], a[60:63], v[188:191], v[80:95]
    ds_read_b128 v[120:123], v250 offset:256
    ds_read_b128 v[124:127], v250 offset:384
    s_add_u32 s90, s90, 0x9e3779b1
    v_cvt_pk_bf16_f32 v208, v208, v208
    v_and_b32 v208, 0xffff0000, v208
    s_waitcnt lgkmcnt(4)
    v_mfma_f32_32x32x16_bf16 v[64:79], a[64:67], v[160:163], v[64:79]
    s_waitcnt vmcnt(6)
    s_barrier
    ds_read_b128 v[176:179], v21 offset:12288
    ds_read_b128 v[180:183], v22 offset:12288
    v_mul_f32 v246, v208, v209
    v_mul_f32 v247, v208, v210
    v_mfma_f32_32x32x16_bf16 v[80:95], a[68:71], v[160:163], v[80:95]
    ds_read_b128 v[184:187], v23 offset:12288
    ds_read_b128 v[188:191], v24 offset:12288
    s_add_u32 m0, s88, 40960
    s_add_u32 s83, s80, s22
    buffer_load_dwordx4 v2, s[40:43], s83 offen lds
    v_mfma_f32_32x32x16_bf16 v[64:79], a[72:75], v[164:167], v[64:79]
    ds_read_b128 a[96:99], v17 offset:24576
    ds_read_b128 a[100:103], v17 offset:28672
    buffer_load_dwordx4 v3, s[40:43], s83 offen offset:1024 lds
    v_mul_f32 v246, 0x3fb8aa3b, v246
    v_mul_f32 v247, 0.15915494, v247
    v_mfma_f32_32x32x16_bf16 v[80:95], a[76:79], v[164:167], v[80:95]
    ds_read_b128 a[104:107], v18 offset:24576
    ds_read_b128 a[108:111], v18 offset:28672
    s_add_u32 m0, s79, 20480
    s_add_u32 s83, s81, s22
    buffer_load_dwordx4 v2, s[44:47], s83 offen offset:0 lds
    v_mfma_f32_32x32x16_bf16 v[64:79], a[80:83], v[168:171], v[64:79]
    ds_read_b128 a[112:115], v19 offset:24576
    ds_read_b128 a[116:119], v19 offset:28672
    buffer_load_dwordx4 v4, s[48:51], s83 offen offset:1024 lds
    v_exp_f32 v246, v246
    v_mfma_f32_32x32x16_bf16 v[80:95], a[84:87], v[168:171], v[80:95]
    ds_read_b128 a[120:123], v20 offset:24576
    ds_read_b128 a[124:127], v20 offset:28672
    buffer_load_dwordx4 v5, s[44:47], s83 offen offset:2048 lds
    v_rndne_f32 v248, v247
    v_sub_f32 v247, v247, v248
    v_mfma_f32_32x32x16_bf16 v[64:79], a[88:91], v[172:175], v[64:79]
    ds_read_b128 v[144:147], v250 offset:512
    ds_read_b128 v[148:151], v250 offset:640
    ds_read_b128 v[152:155], v250 offset:768
    buffer_load_dwordx4 v6, s[48:51], s83 offen offset:3072 lds
    v_cos_f32 v248, v247
    v_mfma_f32_32x32x16_bf16 v[80:95], a[92:95], v[172:175], v[80:95]
    v_sin_f32 v247, v247
    v_mul_f32 v224, v246, v248
    v_mul_f32 v247, v246, v247
    v_lshlrev_b32 v249, 28, v241
    s_waitcnt lgkmcnt(3)
    v_mfma_f32_32x32x16_bf16 a[224:239], v[112:115], a[0:3], 0
    v_and_b32 v249, 0x80000000, v249
    v_xor_b32 v225, v249, v247
    v_mul_f32 v246, v209, v209
    v_fmac_f32 v246, v210, v210
    v_rcp_f32 v246, v246
    v_mfma_f32_32x32x16_bf16 a[240:255], v[112:115], a[4:7], 0
    v_add_f32 v248, -1.0, v224
    v_mul_f32 v234, v248, v209
    v_fmac_f32 v234, v247, v210
    v_mul_f32 v235, v248, v210
    v_fma_f32 v235, -v247, v209, v235
    v_mfma_f32_32x32x16_bf16 v[64:79], a[96:99], v[176:179], v[64:79]
    s_waitcnt vmcnt(6)
    s_barrier
    ds_read_b128 v[160:163], v21 offset:16384
    ds_read_b128 v[164:167], v22 offset:16384
    v_mul_f32 v234, v234, v246
    v_mul_f32 v235, v235, v246
    v_mfma_f32_32x32x16_bf16 v[80:95], a[100:103], v[176:179], v[80:95]
    ds_read_b128 v[168:171], v23 offset:16384
    ds_read_b128 v[172:175], v24 offset:16384
    s_add_u32 m0, s88, 49152
    s_add_u32 s83, s80, s23
    buffer_load_dwordx4 v2, s[40:43], s83 offen lds
    v_mfma_f32_32x32x16_bf16 v[64:79], a[104:107], v[180:183], v[64:79]
    ds_read_b128 a[128:131], v17 offset:32768
    ds_read_b128 a[132:135], v17 offset:36864
    buffer_load_dwordx4 v3, s[40:43], s83 offen offset:1024 lds
    v_xor_b32 v234, v249, v234
    v_mul_f32 v246, v225, v225
    v_mfma_f32_32x32x16_bf16 v[80:95], a[108:111], v[180:183], v[80:95]
    ds_read_b128 a[136:139], v18 offset:32768
    ds_read_b128 a[140:143], v18 offset:36864
    s_add_u32 m0, s79, 0
    s_add_u32 s83, s81, s23
    buffer_load_dwordx4 v2, s[44:47], s83 offen offset:0 lds
    v_mfma_f32_32x32x16_bf16 v[64:79], a[112:115], v[184:187], v[64:79]
    ds_read_b128 a[144:147], v19 offset:32768
    ds_read_b128 a[148:151], v19 offset:36864
    buffer_load_dwordx4 v4, s[48:51], s83 offen offset:1024 lds
    v_add_f32 v248, v224, v224
    v_fma_f32 v226, v224, v224, -v246
    v_mfma_f32_32x32x16_bf16 v[80:95], a[116:119], v[184:187], v[80:95]
    ds_read_b128 a[152:155], v20 offset:32768
    ds_read_b128 a[156:159], v20 offset:36864
    buffer_load_dwordx4 v5, s[44:47], s83 offen offset:2048 lds
    v_mul_f32 v227, v248, v225
    v_mul_f32 v246, v227, v227
    v_mfma_f32_32x32x16_bf16 v[64:79], a[120:123], v[188:191], v[64:79]
    buffer_load_dwordx4 v6, s[48:51], s83 offen offset:3072 lds
    v_add_f32 v248, v226, v226
    v_fma_f32 v228, v226, v226, -v246
    v_mul_f32 v229, v248, v227
    v_mul_f32 v246, v229, v229
    v_mfma_f32_32x32x16_bf16 v[80:95], a[124:127], v[188:191], v[80:95]
    v_add_f32 v248, v228, v228
    v_fma_f32 v226, v228, v228, -v246
    v_mul_f32 v227, v248, v229
    v_mul_f32 v246, v227, v227
    v_add_f32 v248, v226, v226
    v_mfma_f32_32x32x16_bf16 a[224:239], v[116:119], a[32:35], a[224:239]
    v_fma_f32 v230, v226, v226, -v246
    v_mul_f32 v231, v248, v227
    v_mov_b32 v226, v230
    v_mov_b32 v227, v231
    v_mul_f32 v246, v227, v227
    v_mfma_f32_32x32x16_bf16 a[240:255], v[116:119], a[36:39], a[240:255]
    v_add_f32 v248, v226, v226
    v_fma_f32 v228, v226, v226, -v246
    v_mul_f32 v229, v248, v227
    v_mul_f32 v246, v229, v229
    v_add_f32 v248, v228, v228
    s_waitcnt lgkmcnt(0)
    v_mfma_f32_32x32x16_bf16 v[64:79], a[128:131], v[160:163], v[64:79]
    s_waitcnt vmcnt(6)
    s_barrier
    ds_read_b128 v[176:179], v21 offset:20480
    ds_read_b128 v[180:183], v22 offset:20480
    s_add_u32 m0, s79, 4096
    s_mul_i32 s83, s3, 1792
    s_add_u32 s83, s83, s82
    buffer_load_dwordx4 v9, s[52:55], s83 offen offset:0 lds
    v_mfma_f32_32x32x16_bf16 v[80:95], a[132:135], v[160:163], v[80:95]
    ds_read_b128 v[184:187], v23 offset:20480
    ds_read_b128 v[188:191], v24 offset:20480
    v_fma_f32 v230, v228, v228, -v246
    v_mul_f32 v231, v248, v229
    v_mul_f32 v246, v231, v231
    v_mfma_f32_32x32x16_bf16 v[64:79], a[136:139], v[164:167], v[64:79]
    ds_read_b128 a[160:163], v17 offset:40960
    ds_read_b128 a[164:167], v17 offset:45056
    buffer_load_dwordx4 v10, s[52:55], s83 offen offset:1024 lds
    v_add_f32 v248, v230, v230
    v_fma_f32 v232, v230, v230, -v246
    v_mfma_f32_32x32x16_bf16 v[80:95], a[140:143], v[164:167], v[80:95]
    ds_read_b128 a[168:171], v18 offset:40960
    ds_read_b128 a[172:175], v18 offset:45056
    v_mul_f32 v233, v248, v231
    v_cmp_eq_u32 vcc, 0, v242
    s_nop 1
    v_cndmask_b32 v236, v226, 1.0, vcc
    v_mfma_f32_32x32x16_bf16 v[64:79], a[144:147], v[168:171], v[64:79]
    ds_read_b128 a[176:179], v19 offset:40960
    ds_read_b128 a[180:183], v19 offset:45056
    buffer_load_dwordx4 v11, s[52:55], s83 offen offset:2048 lds
    v_cndmask_b32 v237, v227, 0, vcc
    s_add_u32 s84, s78, 1
    v_mfma_f32_32x32x16_bf16 v[80:95], a[148:151], v[168:171], v[80:95]
    ds_read_b128 a[184:187], v20 offset:40960
    ds_read_b128 a[188:191], v20 offset:45056
    v_sub_u32 v246, s84, v242
    v_lshrrev_b32 v246, 1, v246
    v_and_b32 v247, 3, v241
    v_mfma_f32_32x32x16_bf16 v[64:79], a[152:155], v[172:175], v[64:79]
    buffer_load_dwordx4 v12, s[52:55], s83 offen offset:3072 lds
    v_lshlrev_b32 v247, 3, v247
    v_lshrrev_b32 v247, v247, s90
    v_and_b32 v255, 0xff, v247
    v_mul_u32_u24 v58, v246, v255
    v_mfma_f32_32x32x16_bf16 v[80:95], a[156:159], v[172:175], v[80:95]
    ds_read_b128 v[192:195], v251 offset:0
    ds_read_b128 v[196:199], v251 offset:16
    ds_read_b128 v[200:203], v251 offset:64
    ds_read_b128 v[204:207], v251 offset:80
    s_waitcnt lgkmcnt(3)
    v_lshlrev_b32 v96, 16, v192
    v_mfma_f32_32x32x16_bf16 a[224:239], v[120:123], a[64:67], a[224:239]
    s_add_u32 m0, s79, 8192
    s_add_u32 s83, s83, s85
    buffer_load_dwordx4 v9, s[52:55], s83 offen offset:0 lds
    v_and_b32 v97, 0xffff0000, v192
    v_lshlrev_b32 v98, 16, v193
    v_mfma_f32_32x32x16_bf16 a[240:255], v[120:123], a[68:71], a[240:255]
    v_and_b32 v99, 0xffff0000, v193
    v_lshlrev_b32 v100, 16, v194
    v_and_b32 v101, 0xffff0000, v194
    v_lshlrev_b32 v102, 16, v195
    v_and_b32 v103, 0xffff0000, v195
    v_mfma_f32_32x32x16_bf16 a[224:239], v[124:127], a[96:99], a[224:239]
    buffer_load_dwordx4 v10, s[52:55], s83 offen offset:1024 lds
    s_waitcnt lgkmcnt(0)
    v_lshlrev_b32 v104, 16, v196
    v_and_b32 v105, 0xffff0000, v196
    v_lshlrev_b32 v106, 16, v197
    v_and_b32 v107, 0xffff0000, v197
    v_mfma_f32_32x32x16_bf16 a[240:255], v[124:127], a[100:103], a[240:255]
    v_lshlrev_b32 v108, 16, v198
    v_and_b32 v109, 0xffff0000, v198
    v_lshlrev_b32 v110, 16, v199
    v_and_b32 v111, 0xffff0000, v199
    v_lshlrev_b32 v128, 16, v200
    v_mfma_f32_32x32x16_bf16 v[64:79], a[160:163], v[176:179], v[64:79]
    s_waitcnt vmcnt(6)
    s_barrier
    ds_read_b128 v[160:163], v21 offset:0
    ds_read_b128 v[164:167], v22 offset:0
    buffer_load_dwordx4 v11, s[52:55], s83 offen offset:2048 lds
    v_and_b32 v129, 0xffff0000, v200
    v_mfma_f32_32x32x16_bf16 v[80:95], a[164:167], v[176:179], v[80:95]
    ds_read_b128 v[168:171], v23 offset:0
    ds_read_b128 v[172:175], v24 offset:0
    v_lshlrev_b32 v130, 16, v201
    v_and_b32 v131, 0xffff0000, v201
    v_lshlrev_b32 v132, 16, v202
    v_mfma_f32_32x32x16_bf16 v[64:79], a[168:171], v[180:183], v[64:79]
    ds_read_b128 a[192:195], v17 offset:49152
    ds_read_b128 a[196:199], v17 offset:53248
    buffer_load_dwordx4 v12, s[52:55], s83 offen offset:3072 lds
    v_and_b32 v133, 0xffff0000, v202
    v_lshlrev_b32 v134, 16, v203
    v_mfma_f32_32x32x16_bf16 v[80:95], a[172:175], v[180:183], v[80:95]
    ds_read_b128 a[200:203], v18 offset:49152
    ds_read_b128 a[204:207], v18 offset:53248
    v_and_b32 v135, 0xffff0000, v203
    v_lshlrev_b32 v136, 16, v204
    v_and_b32 v137, 0xffff0000, v204
    v_mfma_f32_32x32x16_bf16 v[64:79], a[176:179], v[184:187], v[64:79]
    ds_read_b128 a[208:211], v19 offset:49152
    ds_read_b128 a[212:215], v19 offset:53248
    s_add_u32 m0, s79, 12288
    s_mul_i32 s83, s38, 1792
    s_add_u32 s83, s83, s82
    buffer_load_dwordx4 v9, s[52:55], s83 offen offset:0 lds
    v_mfma_f32_32x32x16_bf16 v[80:95], a[180:183], v[184:187], v[80:95]
    ds_read_b128 a[216:219], v20 offset:49152
    ds_read_b128 a[220:223], v20 offset:53248
    v_lshlrev_b32 v138, 16, v205
    v_and_b32 v139, 0xffff0000, v205
    v_lshlrev_b32 v140, 16, v206
    v_mfma_f32_32x32x16_bf16 v[64:79], a[184:187], v[188:191], v[64:79]
    buffer_load_dwordx4 v10, s[52:55], s83 offen offset:1024 lds
    v_and_b32 v141, 0xffff0000, v206
    v_lshlrev_b32 v142, 16, v207
    v_and_b32 v143, 0xffff0000, v207
    v_mfma_f32_32x32x16_bf16 v[80:95], a[188:191], v[188:191], v[80:95]
    v_mfma_f32_32x32x16_bf16 a[224:239], v[144:147], a[128:131], a[224:239]
    buffer_load_dwordx4 v11, s[52:55], s83 offen offset:2048 lds
    v_mfma_f32_32x32x16_bf16 a[240:255], v[144:147], a[132:135], a[240:255]
    v_mfma_f32_32x32x16_bf16 a[224:239], v[148:151], a[160:163], a[224:239]
    buffer_load_dwordx4 v12, s[52:55], s83 offen offset:3072 lds
    v_mfma_f32_32x32x16_bf16 a[240:255], v[148:151], a[164:167], a[240:255]
    s_waitcnt lgkmcnt(0)
    v_mfma_f32_32x32x16_bf16 v[64:79], a[192:195], v[160:163], v[64:79]
    s_add_u32 m0, s79, 16384
    s_add_u32 s83, s83, s85
    buffer_load_dwordx4 v9, s[52:55], s83 offen offset:0 lds
    v_mfma_f32_32x32x16_bf16 v[80:95], a[196:199], v[160:163], v[80:95]
    v_mfma_f32_32x32x16_bf16 a[224:239], v[152:155], a[192:195], a[224:239]
    s_waitcnt vmcnt(11)
    ds_read_b64_tr_b16 v[176:177], v25 offset:4096
    ds_read_b64_tr_b16 v[178:179], v25 offset:4608
    buffer_load_dwordx4 v10, s[52:55], s83 offen offset:1024 lds
    v_mfma_f32_32x32x16_bf16 a[240:255], v[152:155], a[196:199], a[240:255]
    ds_read_b64_tr_b16 v[180:181], v26 offset:4096
    ds_read_b64_tr_b16 v[182:183], v26 offset:4608
    v_mfma_f32_32x32x16_bf16 v[64:79], a[200:203], v[164:167], v[64:79]
    ds_read_b128 v[184:187], v50
    v_xor_b32 v50, 16, v50
    buffer_load_dwordx4 v11, s[52:55], s83 offen offset:2048 lds
    v_mfma_f32_32x32x16_bf16 v[80:95], a[204:207], v[164:167], v[80:95]
    ds_read_b128 v[188:191], v50
    v_mfma_f32_32x32x16_bf16 v[64:79], a[208:211], v[168:171], v[64:79]
    s_waitcnt vmcnt(11)
    ds_read_b64_tr_b16 v[160:161], v25 offset:6144
    ds_read_b64_tr_b16 v[162:163], v25 offset:6656
    buffer_load_dwordx4 v12, s[52:55], s83 offen offset:3072 lds
    v_mfma_f32_32x32x16_bf16 v[80:95], a[212:215], v[168:171], v[80:95]
    ds_read_b64_tr_b16 v[164:165], v26 offset:6144
    ds_read_b64_tr_b16 v[166:167], v26 offset:6656
    v_mfma_f32_32x32x16_bf16 v[64:79], a[216:219], v[172:175], v[64:79]
    s_add_u32 m0, s79, 20480
    s_mul_i32 s83, s39, 1792
    s_add_u32 s83, s83, s82
    buffer_load_dwordx4 v9, s[52:55], s83 offen offset:0 lds
    v_accvgpr_read_b32 v59, a224
    v_mfma_f32_32x32x16_bf16 v[80:95], a[220:223], v[172:175], v[80:95]
    v_accvgpr_read_b32 v60, a240
    v_cmp_gt_u32 vcc, 32, v1
    v_mov_b32 v238, 0
    s_nop 0
    v_cndmask_b32 v59, v60, v59, vcc
    s_waitcnt lgkmcnt(0)
    v_mfma_f32_32x32x16_bf16 v[112:127], v[176:179], a[4:7], v[96:111]
    s_waitcnt vmcnt(11)
    ds_read_b64_tr_b16 v[168:169], v25 offset:8192
    ds_read_b64_tr_b16 v[170:171], v25 offset:8704
    buffer_load_dwordx4 v10, s[52:55], s83 offen offset:1024 lds
    ds_write_b32 v45, v59
    v_mfma_f32_32x32x16_bf16 v[96:111], v[176:179], a[0:3], v[96:111]
    ds_read_b64_tr_b16 v[172:173], v26 offset:8192
    ds_read_b64_tr_b16 v[174:175], v26 offset:8704
    v_fma_f32 v242, v224, v64, v65
    v_fma_f32 v244, v224, v80, v81
    v_fmac_f32_dpp v242, v64, -v225 row_ror:8 row_mask:0xf bank_mask:0xf
    v_mfma_f32_32x32x16_bf16 v[144:159], v[180:183], a[4:7], v[128:143]
    buffer_load_dwordx4 v11, s[52:55], s83 offen offset:2048 lds
    v_fmac_f32_dpp v244, v80, -v225 row_ror:8 row_mask:0xf bank_mask:0xf
    v_fma_f32 v241, v224, v242, v66
    v_fma_f32 v243, v224, v244, v82
    v_fmac_f32_dpp v241, v242, -v225 row_ror:8 row_mask:0xf bank_mask:0xf
    v_mfma_f32_32x32x16_bf16 v[128:143], v[180:183], a[0:3], v[128:143]
    s_waitcnt lgkmcnt(2)
    s_barrier
    v_fmac_f32_dpp v243, v244, -v225 row_ror:8 row_mask:0xf bank_mask:0xf
    v_fma_f32 v242, v224, v241, v67
    v_fma_f32 v244, v224, v243, v83
    v_fmac_f32_dpp v242, v241, -v225 row_ror:8 row_mask:0xf bank_mask:0xf
    v_mfma_f32_32x32x16_bf16 v[96:111], v[160:163], a[8:11], v[96:111]
    s_waitcnt vmcnt(11)
    ds_read_b64_tr_b16 v[176:177], v25 offset:10240
    ds_read_b64_tr_b16 v[178:179], v25 offset:10752
    buffer_load_dwordx4 v12, s[52:55], s83 offen offset:3072 lds
    v_fmac_f32_dpp v244, v243, -v225 row_ror:8 row_mask:0xf bank_mask:0xf
    v_fma_f32 v241, v224, v242, v68
    v_mfma_f32_32x32x16_bf16 v[112:127], v[160:163], a[12:15], v[112:127]
    ds_read_b64_tr_b16 v[180:181], v26 offset:10240
    ds_read_b64_tr_b16 v[182:183], v26 offset:10752
    v_fma_f32 v243, v224, v244, v84
    v_fmac_f32_dpp v241, v242, -v225 row_ror:8 row_mask:0xf bank_mask:0xf
    v_fmac_f32_dpp v243, v244, -v225 row_ror:8 row_mask:0xf bank_mask:0xf
    v_mfma_f32_32x32x16_bf16 v[128:143], v[164:167], a[8:11], v[128:143]
    s_add_u32 m0, s79, 0
    s_add_u32 s83, s83, s85
    buffer_load_dwordx4 v9, s[52:55], s83 offen offset:0 lds
    v_fma_f32 v242, v224, v241, v69
    v_fma_f32 v244, v224, v243, v85
    v_mfma_f32_32x32x16_bf16 v[144:159], v[164:167], a[12:15], v[144:159]
    v_fmac_f32_dpp v242, v241, -v225 row_ror:8 row_mask:0xf bank_mask:0xf
    v_fmac_f32_dpp v244, v243, -v225 row_ror:8 row_mask:0xf bank_mask:0xf
    v_fma_f32 v241, v224, v242, v70
    v_fma_f32 v243, v224, v244, v86
    v_fmac_f32_dpp v241, v242, -v225 row_ror:8 row_mask:0xf bank_mask:0xf
    v_mfma_f32_32x32x16_bf16 v[96:111], v[168:171], a[16:19], v[96:111]
    s_waitcnt vmcnt(11)
    ds_read_b64_tr_b16 v[160:161], v25 offset:12288
    ds_read_b64_tr_b16 v[162:163], v25 offset:12800
    buffer_load_dwordx4 v10, s[52:55], s83 offen offset:1024 lds
    v_fmac_f32_dpp v243, v244, -v225 row_ror:8 row_mask:0xf bank_mask:0xf
    v_fma_f32 v242, v224, v241, v71
    v_mfma_f32_32x32x16_bf16 v[112:127], v[168:171], a[20:23], v[112:127]
    ds_read_b64_tr_b16 v[164:165], v26 offset:12288
    ds_read_b64_tr_b16 v[166:167], v26 offset:12800
    v_fma_f32 v244, v224, v243, v87
    v_fmac_f32_dpp v242, v241, -v225 row_ror:8 row_mask:0xf bank_mask:0xf
    v_fmac_f32_dpp v244, v243, -v225 row_ror:8 row_mask:0xf bank_mask:0xf
    s_waitcnt lgkmcnt(4)
    v_mfma_f32_32x32x16_bf16 v[128:143], v[172:175], a[16:19], v[128:143]
    buffer_load_dwordx4 v11, s[52:55], s83 offen offset:2048 lds
    v_fma_f32 v241, v224, v242, v72
    v_fma_f32 v243, v224, v244, v88
    v_fmac_f32_dpp v241, v242, -v225 row_ror:8 row_mask:0xf bank_mask:0xf
    v_fmac_f32_dpp v243, v244, -v225 row_ror:8 row_mask:0xf bank_mask:0xf
    v_mfma_f32_32x32x16_bf16 v[144:159], v[172:175], a[20:23], v[144:159]
    v_fma_f32 v242, v224, v241, v73
    v_fma_f32 v244, v224, v243, v89
    v_fmac_f32_dpp v242, v241, -v225 row_ror:8 row_mask:0xf bank_mask:0xf
    v_fmac_f32_dpp v244, v243, -v225 row_ror:8 row_mask:0xf bank_mask:0xf
    v_fma_f32 v241, v224, v242, v74
    v_mfma_f32_32x32x16_bf16 v[96:111], v[176:179], a[24:27], v[96:111]
    s_waitcnt vmcnt(11)
    ds_read_b64_tr_b16 v[168:169], v25 offset:14336
    ds_read_b64_tr_b16 v[170:171], v25 offset:14848
    buffer_load_dwordx4 v12, s[52:55], s83 offen offset:3072 lds
    v_fma_f32 v243, v224, v244, v90
    v_fmac_f32_dpp v241, v242, -v225 row_ror:8 row_mask:0xf bank_mask:0xf
    v_mfma_f32_32x32x16_bf16 v[112:127], v[176:179], a[28:31], v[112:127]
    ds_read_b64_tr_b16 v[172:173], v26 offset:14336
    ds_read_b64_tr_b16 v[174:175], v26 offset:14848
    v_fmac_f32_dpp v243, v244, -v225 row_ror:8 row_mask:0xf bank_mask:0xf
    v_fma_f32 v242, v224, v241, v75
    v_fma_f32 v244, v224, v243, v91
    v_mfma_f32_32x32x16_bf16 v[128:143], v[180:183], a[24:27], v[128:143]
    s_add_u32 m0, s79, 4096
    s_mul_i32 s83, s96, 1792
    s_add_u32 s83, s83, s82
    buffer_load_dwordx4 v9, s[52:55], s83 offen offset:0 lds
    v_fmac_f32_dpp v242, v241, -v225 row_ror:8 row_mask:0xf bank_mask:0xf
    v_mfma_f32_32x32x16_bf16 v[144:159], v[180:183], a[28:31], v[144:159]
    buffer_load_dwordx4 v10, s[52:55], s83 offen offset:1024 lds
    v_fmac_f32_dpp v244, v243, -v225 row_ror:8 row_mask:0xf bank_mask:0xf
    v_fma_f32 v241, v224, v242, v76
    v_fma_f32 v243, v224, v244, v92
    v_fmac_f32_dpp v241, v242, -v225 row_ror:8 row_mask:0xf bank_mask:0xf
    s_waitcnt lgkmcnt(0)
    v_mfma_f32_32x32x16_bf16 v[96:111], v[160:163], a[32:35], v[96:111]
    s_waitcnt vmcnt(12)
    ds_read_b64_tr_b16 v[176:177], v25 offset:16384
    ds_read_b64_tr_b16 v[178:179], v25 offset:16896
    buffer_load_dwordx4 v11, s[52:55], s83 offen offset:2048 lds
    v_fmac_f32_dpp v243, v244, -v225 row_ror:8 row_mask:0xf bank_mask:0xf
    v_fma_f32 v242, v224, v241, v77
    v_mfma_f32_32x32x16_bf16 v[112:127], v[160:163], a[36:39], v[112:127]
    ds_read_b64_tr_b16 v[180:181], v26 offset:16384
    ds_read_b64_tr_b16 v[182:183], v26 offset:16896
    buffer_load_dwordx4 v12, s[52:55], s83 offen offset:3072 lds
    v_fma_f32 v244, v224, v243, v93
    v_fmac_f32_dpp v242, v241, -v225 row_ror:8 row_mask:0xf bank_mask:0xf
    v_mfma_f32_32x32x16_bf16 v[128:143], v[164:167], a[32:35], v[128:143]
    s_add_u32 m0, s79, 8192
    s_add_u32 s83, s83, s85
    buffer_load_dwordx4 v9, s[52:55], s83 offen offset:0 lds
    v_fmac_f32_dpp v244, v243, -v225 row_ror:8 row_mask:0xf bank_mask:0xf
    v_fma_f32 v241, v224, v242, v78
    v_mfma_f32_32x32x16_bf16 v[144:159], v[164:167], a[36:39], v[144:159]
    buffer_load_dwordx4 v10, s[52:55], s83 offen offset:1024 lds
    v_fma_f32 v243, v224, v244, v94
    v_fmac_f32_dpp v241, v242, -v225 row_ror:8 row_mask:0xf bank_mask:0xf
    v_fmac_f32_dpp v243, v244, -v225 row_ror:8 row_mask:0xf bank_mask:0xf
    v_fma_f32 v242, v224, v241, v79
    v_mfma_f32_32x32x16_bf16 v[96:111], v[168:171], a[40:43], v[96:111]
    s_waitcnt vmcnt(14)
    ds_read_b64_tr_b16 v[160:161], v25 offset:18432
    ds_read_b64_tr_b16 v[162:163], v25 offset:18944
    buffer_load_dwordx4 v11, s[52:55], s83 offen offset:2048 lds
    v_fma_f32 v244, v224, v243, v95
    v_fmac_f32_dpp v242, v241, -v225 row_ror:8 row_mask:0xf bank_mask:0xf
    v_mfma_f32_32x32x16_bf16 v[112:127], v[168:171], a[44:47], v[112:127]
    ds_read_b64_tr_b16 v[164:165], v26 offset:18432
    ds_read_b64_tr_b16 v[166:167], v26 offset:18944
    buffer_load_dwordx4 v12, s[52:55], s83 offen offset:3072 lds
    v_fmac_f32_dpp v244, v243, -v225 row_ror:8 row_mask:0xf bank_mask:0xf
    v_mul_f32_dpp v245, v242, v235 row_ror:8 row_mask:0xf bank_mask:0xf
    v_mfma_f32_32x32x16_bf16 v[128:143], v[172:175], a[40:43], v[128:143]
    s_add_u32 m0, s79, 12288
    s_mul_i32 s83, s97, 1792
    s_add_u32 s83, s83, s82
    buffer_load_dwordx4 v9, s[52:55], s83 offen offset:0 lds
    v_mul_f32_dpp v246, v244, v235 row_ror:8 row_mask:0xf bank_mask:0xf
    v_mfma_f32_32x32x16_bf16 v[144:159], v[172:175], a[44:47], v[144:159]
    buffer_load_dwordx4 v10, s[52:55], s83 offen offset:1024 lds
    v_fmac_f32 v245, v234, v242
    v_fmac_f32 v246, v234, v244
    s_nop 1
    v_permlane32_swap_b32 v245, v246
    v_fmac_f32 v246, v226, v245
    s_waitcnt lgkmcnt(0)
    v_mfma_f32_32x32x16_bf16 v[96:111], v[176:179], a[48:51], v[96:111]
    s_waitcnt vmcnt(16)
    ds_read_b64_tr_b16 v[168:169], v25 offset:20480
    ds_read_b64_tr_b16 v[170:171], v25 offset:20992
    buffer_load_dwordx4 v11, s[52:55], s83 offen offset:2048 lds
    v_fmac_f32_dpp v246, v245, v227 row_ror:8 row_mask:0xf bank_mask:0xf
    v_mov_b32 v240, v246
    v_mfma_f32_32x32x16_bf16 v[112:127], v[176:179], a[52:55], v[112:127]
    ds_read_b64_tr_b16 v[172:173], v26 offset:20480
    ds_read_b64_tr_b16 v[174:175], v26 offset:20992
    buffer_load_dwordx4 v12, s[52:55], s83 offen offset:3072 lds
    v_mov_b32 v239, v245
    v_permlane32_swap_b32 v240, v246
    v_mfma_f32_32x32x16_bf16 v[128:143], v[180:183], a[48:51], v[128:143]
    v_permlane32_swap_b32 v238, v239
    v_fmac_f32 v246, v228, v240
    v_fmac_f32_dpp v246, v240, v229 row_ror:8 row_mask:0xf bank_mask:0xf
    v_and_b32 v246, 0xffffff00, v246
    v_or_b32 v246, v255, v246
    v_mfma_f32_32x32x16_bf16 v[144:159], v[180:183], a[52:55], v[144:159]
    buffer_store_dword v246, v44, s[64:67], 0 offen sc1
    ds_read_b128 v[192:195], v46
    ds_read_b128 v[196:199], v46 offset:512
    v_mul_f32_dpp v59, v64, v235 row_ror:8 row_mask:0xf bank_mask:0xf
    v_mul_f32_dpp v60, v65, v235 row_ror:8 row_mask:0xf bank_mask:0xf
    v_mfma_f32_32x32x16_bf16 v[96:111], v[160:163], a[56:59], v[96:111]
    s_waitcnt vmcnt(17)
    ds_read_b64_tr_b16 v[176:177], v25 offset:22528
    ds_read_b64_tr_b16 v[178:179], v25 offset:23040
    v_fma_f32 v64, v234, v64, v59
    v_fma_f32 v65, v234, v65, v60
    v_mul_f32_dpp v59, v66, v235 row_ror:8 row_mask:0xf bank_mask:0xf
    v_mfma_f32_32x32x16_bf16 v[112:127], v[160:163], a[60:63], v[112:127]
    ds_read_b64_tr_b16 v[180:181], v26 offset:22528
    ds_read_b64_tr_b16 v[182:183], v26 offset:23040
    v_mul_f32_dpp v60, v67, v235 row_ror:8 row_mask:0xf bank_mask:0xf
    v_fma_f32 v66, v234, v66, v59
    v_fma_f32 v67, v234, v67, v60
    v_mfma_f32_32x32x16_bf16 v[128:143], v[164:167], a[56:59], v[128:143]
    s_add_u32 m0, s79, 16384
    s_add_u32 s83, s83, s85
    buffer_load_dwordx4 v9, s[52:55], s83 offen offset:0 lds
    v_mul_f32_dpp v59, v68, v235 row_ror:8 row_mask:0xf bank_mask:0xf
    v_mul_f32_dpp v60, v69, v235 row_ror:8 row_mask:0xf bank_mask:0xf
    v_mfma_f32_32x32x16_bf16 v[144:159], v[164:167], a[60:63], v[144:159]
    buffer_load_dwordx4 v10, s[52:55], s83 offen offset:1024 lds
    v_fma_f32 v68, v234, v68, v59
    v_fma_f32 v69, v234, v69, v60
    v_mul_f32_dpp v59, v70, v235 row_ror:8 row_mask:0xf bank_mask:0xf
    v_mul_f32_dpp v60, v71, v235 row_ror:8 row_mask:0xf bank_mask:0xf
    s_waitcnt lgkmcnt(0)
    v_mfma_f32_32x32x16_bf16 v[96:111], v[168:171], a[64:67], v[96:111]
    s_waitcnt vmcnt(17)
    ds_read_b64_tr_b16 v[160:161], v25 offset:0
    ds_read_b64_tr_b16 v[162:163], v25 offset:512
    buffer_load_dwordx4 v11, s[52:55], s83 offen offset:2048 lds
    v_fma_f32 v70, v234, v70, v59
    v_fma_f32 v71, v234, v71, v60
    v_mfma_f32_32x32x16_bf16 v[112:127], v[168:171], a[68:71], v[112:127]
    ds_read_b64_tr_b16 v[164:165], v26 offset:0
    ds_read_b64_tr_b16 v[166:167], v26 offset:512
    buffer_load_dwordx4 v12, s[52:55], s83 offen offset:3072 lds
    v_add_f32 v192, v192, v193
    v_add_f32 v196, v196, v197
    v_mfma_f32_32x32x16_bf16 v[128:143], v[172:175], a[64:67], v[128:143]
    v_add_f32 v194, v194, v195
    v_add_f32 v198, v198, v199
    v_add_f32 v192, v192, v194
    v_add_f32 v196, v196, v198
    v_cvt_pk_bf16_f32 v192, v192, v192
    v_mfma_f32_32x32x16_bf16 v[144:159], v[172:175], a[68:71], v[144:159]
    v_cvt_pk_bf16_f32 v196, v196, v196
    v_and_b32 v192, 0xffff0000, v192
    v_and_b32 v196, 0xffff0000, v196
    v_mul_f32 v192, 0xbfb8aa3b, v192
    v_mul_f32 v196, 0xbfb8aa3b, v196
    v_mfma_f32_32x32x16_bf16 v[96:111], v[176:179], a[72:75], v[96:111]
    s_waitcnt vmcnt(17)
    ds_read_b64_tr_b16 v[168:169], v25 offset:2048
    ds_read_b64_tr_b16 v[170:171], v25 offset:2560
    v_exp_f32 v192, v192
    v_exp_f32 v196, v196
    v_mfma_f32_32x32x16_bf16 v[112:127], v[176:179], a[76:79], v[112:127]
    ds_read_b64_tr_b16 v[172:173], v26 offset:2048
    ds_read_b64_tr_b16 v[174:175], v26 offset:2560
    v_add_f32 v192, 1.0, v192
    v_add_f32 v196, 1.0, v196
    v_rcp_f32 v192, v192
    v_mfma_f32_32x32x16_bf16 v[128:143], v[180:183], a[72:75], v[128:143]
    s_add_u32 m0, s79, 20480
    s_mul_i32 s83, s22, 1792
    s_add_u32 s83, s83, s82
    buffer_load_dwordx4 v9, s[52:55], s83 offen offset:0 lds
    v_rcp_f32 v196, v196
    v_mfma_f32_32x32x16_bf16 v[144:159], v[180:183], a[76:79], v[144:159]
    buffer_load_dwordx4 v10, s[52:55], s83 offen offset:1024 lds
    v_cvt_pk_bf16_f32 v192, v192, v192
    v_cvt_pk_bf16_f32 v196, v196, v196
    v_and_b32 v200, 0xffff0000, v192
    v_and_b32 v201, 0xffff0000, v196
    s_waitcnt lgkmcnt(0)
    v_mfma_f32_32x32x16_bf16 v[96:111], v[160:163], a[80:83], v[96:111]
    s_waitcnt vmcnt(17)
    ds_read_b64_tr_b16 v[176:177], v25 offset:4096
    ds_read_b64_tr_b16 v[178:179], v25 offset:4608
    buffer_load_dwordx4 v11, s[52:55], s83 offen offset:2048 lds
    v_sub_f32 v192, 1.0, v200
    v_sub_f32 v196, 1.0, v201
    v_mfma_f32_32x32x16_bf16 v[112:127], v[160:163], a[84:87], v[112:127]
    ds_read_b64_tr_b16 v[180:181], v26 offset:4096
    ds_read_b64_tr_b16 v[182:183], v26 offset:4608
    buffer_load_dwordx4 v12, s[52:55], s83 offen offset:3072 lds
    v_cvt_pk_bf16_f32 v192, v192, v192
    v_cvt_pk_bf16_f32 v196, v196, v196
    v_mfma_f32_32x32x16_bf16 v[128:143], v[164:167], a[80:83], v[128:143]
    v_and_b32 v202, 0xffff0000, v192
    v_and_b32 v203, 0xffff0000, v196
    v_max_f32 v192, 0x0da24260, v202
    v_max_f32 v196, 0x0da24260, v203
    v_rcp_f32 v54, v192
    v_mfma_f32_32x32x16_bf16 v[144:159], v[164:167], a[84:87], v[144:159]
    v_rcp_f32 v55, v196
    v_cndmask_b32 v192, v201, v200, vcc
    s_cmp_ge_u32 s76, 2
    s_cselect_b64 vcc, -1, 0
    v_mfma_f32_32x32x16_bf16 v[96:111], v[168:171], a[88:91], v[96:111]
    s_waitcnt vmcnt(17)
    ds_read_b64_tr_b16 v[160:161], v25 offset:6144
    ds_read_b64_tr_b16 v[162:163], v25 offset:6656
    v_add_f32 v192, v192, v192
    v_cndmask_b32 v56, v200, v201, vcc
    v_cndmask_b32 v57, v202, v203, vcc
    v_mfma_f32_32x32x16_bf16 v[112:127], v[168:171], a[92:95], v[112:127]
    ds_read_b64_tr_b16 v[164:165], v26 offset:6144
    ds_read_b64_tr_b16 v[166:167], v26 offset:6656
    ds_write_b32 v47, v192
    v_mul_f32_dpp v59, v72, v235 row_ror:8 row_mask:0xf bank_mask:0xf
    v_mul_f32_dpp v60, v73, v235 row_ror:8 row_mask:0xf bank_mask:0xf
    v_mfma_f32_32x32x16_bf16 v[128:143], v[172:175], a[88:91], v[128:143]
    s_add_u32 m0, s79, 0
    s_add_u32 s83, s83, s85
    buffer_load_dwordx4 v9, s[52:55], s83 offen offset:0 lds
    v_fma_f32 v72, v234, v72, v59
    v_fma_f32 v73, v234, v73, v60
    v_mfma_f32_32x32x16_bf16 v[144:159], v[172:175], a[92:95], v[144:159]
    buffer_load_dwordx4 v10, s[52:55], s83 offen offset:1024 lds
    v_mul_f32_dpp v59, v74, v235 row_ror:8 row_mask:0xf bank_mask:0xf
    v_mul_f32_dpp v60, v75, v235 row_ror:8 row_mask:0xf bank_mask:0xf
    v_fma_f32 v74, v234, v74, v59
    v_fma_f32 v75, v234, v75, v60
    s_waitcnt lgkmcnt(0)
    v_mfma_f32_32x32x16_bf16 v[96:111], v[176:179], a[96:99], v[96:111]
    s_waitcnt vmcnt(17)
    ds_read_b64_tr_b16 v[168:169], v25 offset:8192
    ds_read_b64_tr_b16 v[170:171], v25 offset:8704
    buffer_load_dwordx4 v11, s[52:55], s83 offen offset:2048 lds
    v_mul_f32_dpp v59, v76, v235 row_ror:8 row_mask:0xf bank_mask:0xf
    v_mul_f32_dpp v60, v77, v235 row_ror:8 row_mask:0xf bank_mask:0xf
    v_mfma_f32_32x32x16_bf16 v[112:127], v[176:179], a[100:103], v[112:127]
    ds_read_b64_tr_b16 v[172:173], v26 offset:8192
    ds_read_b64_tr_b16 v[174:175], v26 offset:8704
    buffer_load_dwordx4 v12, s[52:55], s83 offen offset:3072 lds
    v_fma_f32 v76, v234, v76, v59
    v_fma_f32 v77, v234, v77, v60
    v_mfma_f32_32x32x16_bf16 v[128:143], v[180:183], a[96:99], v[128:143]
    v_mul_f32_dpp v59, v78, v235 row_ror:8 row_mask:0xf bank_mask:0xf
    v_mul_f32_dpp v60, v79, v235 row_ror:8 row_mask:0xf bank_mask:0xf
    v_fma_f32 v78, v234, v78, v59
    v_fma_f32 v79, v234, v79, v60
    v_mul_f32_dpp v59, v80, v235 row_ror:8 row_mask:0xf bank_mask:0xf
    v_mfma_f32_32x32x16_bf16 v[144:159], v[180:183], a[100:103], v[144:159]
    v_mul_f32_dpp v60, v81, v235 row_ror:8 row_mask:0xf bank_mask:0xf
    v_fma_f32 v80, v234, v80, v59
    v_fma_f32 v81, v234, v81, v60
    v_mul_f32_dpp v59, v82, v235 row_ror:8 row_mask:0xf bank_mask:0xf
    v_mul_f32_dpp v60, v83, v235 row_ror:8 row_mask:0xf bank_mask:0xf
    v_mfma_f32_32x32x16_bf16 v[96:111], v[160:163], a[104:107], v[96:111]
    s_waitcnt vmcnt(17)
    ds_read_b64_tr_b16 v[176:177], v25 offset:10240
    ds_read_b64_tr_b16 v[178:179], v25 offset:10752
    v_fma_f32 v82, v234, v82, v59
    v_fma_f32 v83, v234, v83, v60
    v_mul_f32_dpp v59, v84, v235 row_ror:8 row_mask:0xf bank_mask:0xf
    v_mfma_f32_32x32x16_bf16 v[112:127], v[160:163], a[108:111], v[112:127]
    ds_read_b64_tr_b16 v[180:181], v26 offset:10240
    ds_read_b64_tr_b16 v[182:183], v26 offset:10752
    v_mul_f32_dpp v60, v85, v235 row_ror:8 row_mask:0xf bank_mask:0xf
    v_fma_f32 v84, v234, v84, v59
    v_fma_f32 v85, v234, v85, v60
    v_mfma_f32_32x32x16_bf16 v[128:143], v[164:167], a[104:107], v[128:143]
    s_add_u32 m0, s79, 4096
    s_mul_i32 s83, s23, 1792
    s_add_u32 s83, s83, s82
    buffer_load_dwordx4 v9, s[52:55], s83 offen offset:0 lds
    v_mul_f32_dpp v59, v86, v235 row_ror:8 row_mask:0xf bank_mask:0xf
    v_mfma_f32_32x32x16_bf16 v[144:159], v[164:167], a[108:111], v[144:159]
    buffer_load_dwordx4 v10, s[52:55], s83 offen offset:1024 lds
    v_mul_f32_dpp v60, v87, v235 row_ror:8 row_mask:0xf bank_mask:0xf
    v_fma_f32 v86, v234, v86, v59
    v_fma_f32 v87, v234, v87, v60
    v_mul_f32_dpp v59, v88, v235 row_ror:8 row_mask:0xf bank_mask:0xf
    s_waitcnt lgkmcnt(0)
    v_mfma_f32_32x32x16_bf16 v[96:111], v[168:171], a[112:115], v[96:111]
    s_waitcnt vmcnt(17)
    ds_read_b64_tr_b16 v[160:161], v25 offset:12288
    ds_read_b64_tr_b16 v[162:163], v25 offset:12800
    buffer_load_dwordx4 v11, s[52:55], s83 offen offset:2048 lds
    v_mul_f32_dpp v60, v89, v235 row_ror:8 row_mask:0xf bank_mask:0xf
    v_fma_f32 v88, v234, v88, v59
    v_mfma_f32_32x32x16_bf16 v[112:127], v[168:171], a[116:119], v[112:127]
    ds_read_b64_tr_b16 v[164:165], v26 offset:12288
    ds_read_b64_tr_b16 v[166:167], v26 offset:12800
    buffer_load_dwordx4 v12, s[52:55], s83 offen offset:3072 lds
    v_fma_f32 v89, v234, v89, v60
    v_mul_f32_dpp v59, v90, v235 row_ror:8 row_mask:0xf bank_mask:0xf
    v_mfma_f32_32x32x16_bf16 v[128:143], v[172:175], a[112:115], v[128:143]
    v_mul_f32_dpp v60, v91, v235 row_ror:8 row_mask:0xf bank_mask:0xf
    v_fma_f32 v90, v234, v90, v59
    v_fma_f32 v91, v234, v91, v60
    v_mul_f32_dpp v59, v92, v235 row_ror:8 row_mask:0xf bank_mask:0xf
    v_mul_f32_dpp v60, v93, v235 row_ror:8 row_mask:0xf bank_mask:0xf
    v_mfma_f32_32x32x16_bf16 v[144:159], v[172:175], a[116:119], v[144:159]
    v_fma_f32 v92, v234, v92, v59
    v_fma_f32 v93, v234, v93, v60
    v_mul_f32_dpp v59, v94, v235 row_ror:8 row_mask:0xf bank_mask:0xf
    v_mul_f32_dpp v60, v95, v235 row_ror:8 row_mask:0xf bank_mask:0xf
    v_fma_f32 v94, v234, v94, v59
    v_mfma_f32_32x32x16_bf16 v[96:111], v[176:179], a[120:123], v[96:111]
    s_waitcnt vmcnt(17)
    ds_read_b64_tr_b16 v[168:169], v25 offset:14336
    ds_read_b64_tr_b16 v[170:171], v25 offset:14848
    v_fma_f32 v95, v234, v95, v60
    s_lshl_b32 s88, s77, 13
    s_lshl_b32 s84, s76, 11
    v_mfma_f32_32x32x16_bf16 v[112:127], v[176:179], a[124:127], v[112:127]
    ds_read_b64_tr_b16 v[172:173], v26 offset:14336
    ds_read_b64_tr_b16 v[174:175], v26 offset:14848
    s_add_u32 s88, s88, s84
    v_mfma_f32_32x32x16_bf16 v[128:143], v[180:183], a[120:123], v[128:143]
    s_add_u32 m0, s79, 8192
    s_add_u32 s83, s83, s85
    buffer_load_dwordx4 v9, s[52:55], s83 offen offset:0 lds
    v_mfma_f32_32x32x16_bf16 v[144:159], v[180:183], a[124:127], v[144:159]
    buffer_load_dwordx4 v10, s[52:55], s83 offen offset:1024 lds
    s_waitcnt lgkmcnt(0)
    v_mfma_f32_32x32x16_bf16 v[96:111], v[160:163], a[128:131], v[96:111]
    s_waitcnt vmcnt(16)
    ds_read_b64_tr_b16 v[176:177], v25 offset:16384
    ds_read_b64_tr_b16 v[178:179], v25 offset:16896
    buffer_load_dwordx4 v11, s[52:55], s83 offen offset:2048 lds
    v_mfma_f32_32x32x16_bf16 v[112:127], v[160:163], a[132:135], v[112:127]
    ds_read_b64_tr_b16 v[180:181], v26 offset:16384
    ds_read_b64_tr_b16 v[182:183], v26 offset:16896
    buffer_load_dwordx4 v12, s[52:55], s83 offen offset:3072 lds
    v_mfma_f32_32x32x16_bf16 v[128:143], v[164:167], a[128:131], v[128:143]
    v_mfma_f32_32x32x16_bf16 v[144:159], v[164:167], a[132:135], v[144:159]
    v_mfma_f32_32x32x16_bf16 v[96:111], v[168:171], a[136:139], v[96:111]
    s_waitcnt vmcnt(16)
    ds_read_b64_tr_b16 v[160:161], v25 offset:18432
    ds_read_b64_tr_b16 v[162:163], v25 offset:18944
    v_mfma_f32_32x32x16_bf16 v[112:127], v[168:171], a[140:143], v[112:127]
    ds_read_b64_tr_b16 v[164:165], v26 offset:18432
    ds_read_b64_tr_b16 v[166:167], v26 offset:18944
    v_mfma_f32_32x32x16_bf16 v[128:143], v[172:175], a[136:139], v[128:143]
    s_add_u32 m0, s79, 12288
    s_bfe_u32 s83, s0, 0x30000
    s_mul_i32 s83, s83, 57344
    s_add_u32 s83, s83, s87
    buffer_load_dwordx4 v2, s[60:63], s83 offen offset:0 lds
    v_mfma_f32_32x32x16_bf16 v[144:159], v[172:175], a[140:143], v[144:159]
    buffer_load_dwordx4 v3, s[60:63], s83 offen offset:1024 lds
    s_waitcnt lgkmcnt(0)
    v_mfma_f32_32x32x16_bf16 v[96:111], v[176:179], a[144:147], v[96:111]
    s_waitcnt vmcnt(16)
    ds_read_b64_tr_b16 v[168:169], v25 offset:20480
    ds_read_b64_tr_b16 v[170:171], v25 offset:20992
    buffer_load_dwordx4 v7, s[60:63], s83 offen offset:2048 lds
    v_mfma_f32_32x32x16_bf16 v[112:127], v[176:179], a[148:151], v[112:127]
    ds_read_b64_tr_b16 v[172:173], v26 offset:20480
    ds_read_b64_tr_b16 v[174:175], v26 offset:20992
    buffer_load_dwordx4 v8, s[60:63], s83 offen offset:3072 lds
    v_mfma_f32_32x32x16_bf16 v[128:143], v[180:183], a[144:147], v[128:143]
    v_mfma_f32_32x32x16_bf16 v[144:159], v[180:183], a[148:151], v[144:159]
    v_mfma_f32_32x32x16_bf16 v[96:111], v[160:163], a[152:155], v[96:111]
    s_waitcnt vmcnt(16)
    ds_read_b64_tr_b16 v[176:177], v25 offset:22528
    ds_read_b64_tr_b16 v[178:179], v25 offset:23040
    v_mfma_f32_32x32x16_bf16 v[112:127], v[160:163], a[156:159], v[112:127]
    ds_read_b64_tr_b16 v[180:181], v26 offset:22528
    ds_read_b64_tr_b16 v[182:183], v26 offset:23040
    v_mfma_f32_32x32x16_bf16 v[128:143], v[164:167], a[152:155], v[128:143]
    s_add_u32 m0, s79, 16384
    s_bfe_u32 s83, s0, 0x30000
    s_lshl_b32 s83, s83, 7
    s_add_u32 s83, s83, s86
    buffer_load_dwordx4 v13, s[56:59], s83 offen offset:0 lds
    v_mfma_f32_32x32x16_bf16 v[144:159], v[164:167], a[156:159], v[144:159]
    buffer_load_dwordx4 v14, s[56:59], s83 offen offset:1024 lds
    s_waitcnt lgkmcnt(0)
    v_mfma_f32_32x32x16_bf16 v[96:111], v[168:171], a[160:163], v[96:111]
    s_waitcnt vmcnt(16)
    ds_read_b64_tr_b16 v[160:161], v25 offset:0
    ds_read_b64_tr_b16 v[162:163], v25 offset:512
    buffer_load_dwordx4 v15, s[56:59], s83 offen offset:2048 lds
    v_mfma_f32_32x32x16_bf16 v[112:127], v[168:171], a[164:167], v[112:127]
    ds_read_b64_tr_b16 v[164:165], v26 offset:0
    ds_read_b64_tr_b16 v[166:167], v26 offset:512
    buffer_load_dwordx4 v16, s[56:59], s83 offen offset:3072 lds
    v_mfma_f32_32x32x16_bf16 v[128:143], v[172:175], a[160:163], v[128:143]
    s_mov_b32 m0, s34
    s_nop 0
    buffer_load_dwordx4 v42, s[64:67], 0 offen offset:0 sc1 lds
    v_mfma_f32_32x32x16_bf16 v[144:159], v[172:175], a[164:167], v[144:159]
    buffer_load_dwordx4 v42, s[64:67], 0 offen offset:1024 sc1 lds
    v_mfma_f32_32x32x16_bf16 v[96:111], v[176:179], a[168:171], v[96:111]
    s_waitcnt vmcnt(18)
    ds_read_b64_tr_b16 v[168:169], v25 offset:2048
    ds_read_b64_tr_b16 v[170:171], v25 offset:2560
    buffer_load_dwordx4 v42, s[64:67], 0 offen offset:2048 sc1 lds
    v_mfma_f32_32x32x16_bf16 v[112:127], v[176:179], a[172:175], v[112:127]
    ds_read_b64_tr_b16 v[172:173], v26 offset:2048
    ds_read_b64_tr_b16 v[174:175], v26 offset:2560
    buffer_load_dwordx4 v42, s[64:67], 0 offen offset:3072 sc1 lds
    v_mfma_f32_32x32x16_bf16 v[128:143], v[180:183], a[168:171], v[128:143]
    s_add_u32 m0, s79, 20480
    s_add_u32 s83, s83, 114688
    buffer_load_dwordx4 v13, s[56:59], s83 offen offset:0 lds
    v_mfma_f32_32x32x16_bf16 v[144:159], v[180:183], a[172:175], v[144:159]
    buffer_load_dwordx4 v14, s[56:59], s83 offen offset:1024 lds
    s_waitcnt lgkmcnt(0)
    v_mfma_f32_32x32x16_bf16 v[96:111], v[160:163], a[176:179], v[96:111]
    s_waitcnt vmcnt(20)
    ds_read_b64_tr_b16 v[176:177], v25 offset:4096
    ds_read_b64_tr_b16 v[178:179], v25 offset:4608
    buffer_load_dwordx4 v15, s[56:59], s83 offen offset:2048 lds
    v_mfma_f32_32x32x16_bf16 v[112:127], v[160:163], a[180:183], v[112:127]
    ds_read_b64_tr_b16 v[180:181], v26 offset:4096
    ds_read_b64_tr_b16 v[182:183], v26 offset:4608
    buffer_load_dwordx4 v16, s[56:59], s83 offen offset:3072 lds
    v_mfma_f32_32x32x16_bf16 v[128:143], v[164:167], a[176:179], v[128:143]
    v_mfma_f32_32x32x16_bf16 v[144:159], v[164:167], a[180:183], v[144:159]
    v_mfma_f32_32x32x16_bf16 v[96:111], v[168:171], a[184:187], v[96:111]
    s_waitcnt vmcnt(20)
    ds_read_b64_tr_b16 v[160:161], v25 offset:6144
    ds_read_b64_tr_b16 v[162:163], v25 offset:6656
    v_mfma_f32_32x32x16_bf16 v[112:127], v[168:171], a[188:191], v[112:127]
    ds_read_b64_tr_b16 v[164:165], v26 offset:6144
    ds_read_b64_tr_b16 v[166:167], v26 offset:6656
    v_mfma_f32_32x32x16_bf16 v[128:143], v[172:175], a[184:187], v[128:143]
    s_add_u32 m0, s79, 0
    s_bfe_u32 s83, s0, 0x30003
    s_mul_i32 s83, s83, 57344
    s_add_u32 s83, s83, s87
    buffer_load_dwordx4 v2, s[60:63], s83 offen offset:0 lds
    v_mfma_f32_32x32x16_bf16 v[144:159], v[172:175], a[188:191], v[144:159]
    buffer_load_dwordx4 v3, s[60:63], s83 offen offset:1024 lds
    s_waitcnt lgkmcnt(0)
    v_mfma_f32_32x32x16_bf16 v[96:111], v[176:179], a[192:195], v[96:111]
    s_waitcnt vmcnt(20)
    ds_read_b64_tr_b16 v[168:169], v25 offset:8192
    ds_read_b64_tr_b16 v[170:171], v25 offset:8704
    buffer_load_dwordx4 v7, s[60:63], s83 offen offset:2048 lds
    v_mfma_f32_32x32x16_bf16 v[112:127], v[176:179], a[196:199], v[112:127]
    ds_read_b64_tr_b16 v[172:173], v26 offset:8192
    ds_read_b64_tr_b16 v[174:175], v26 offset:8704
    buffer_load_dwordx4 v8, s[60:63], s83 offen offset:3072 lds
    v_mfma_f32_32x32x16_bf16 v[128:143], v[180:183], a[192:195], v[128:143]
    v_mfma_f32_32x32x16_bf16 v[144:159], v[180:183], a[196:199], v[144:159]
    v_mfma_f32_32x32x16_bf16 v[96:111], v[160:163], a[200:203], v[96:111]
    s_waitcnt vmcnt(20)
    ds_read_b64_tr_b16 v[176:177], v25 offset:10240
    ds_read_b64_tr_b16 v[178:179], v25 offset:10752
    s_waitcnt vmcnt(8)
    ds_read2st64_b32 v[192:193], v43 offset0:0 offset1:1
    ds_read2st64_b32 v[194:195], v43 offset0:2 offset1:3
    ds_read2st64_b32 v[196:197], v43 offset0:4 offset1:5
    v_mfma_f32_32x32x16_bf16 v[112:127], v[160:163], a[204:207], v[112:127]
    ds_read_b64_tr_b16 v[180:181], v26 offset:10240
    ds_read_b64_tr_b16 v[182:183], v26 offset:10752
    ds_read2st64_b32 v[198:199], v43 offset0:6 offset1:7
    ds_read2st64_b32 v[200:201], v43 offset0:8 offset1:9
    ds_read2st64_b32 v[202:203], v43 offset0:10 offset1:11
    v_mfma_f32_32x32x16_bf16 v[128:143], v[164:167], a[200:203], v[128:143]
    s_add_u32 m0, s79, 4096
    s_bfe_u32 s83, s0, 0x30003
    s_lshl_b32 s83, s83, 7
    s_add_u32 s83, s83, s86
    buffer_load_dwordx4 v13, s[56:59], s83 offen offset:0 lds
    v_mfma_f32_32x32x16_bf16 v[144:159], v[164:167], a[204:207], v[144:159]
    buffer_load_dwordx4 v14, s[56:59], s83 offen offset:1024 lds
    ds_read2st64_b32 v[204:205], v43 offset0:12 offset1:13
    ds_read2st64_b32 v[206:207], v43 offset0:14 offset1:15
    s_waitcnt lgkmcnt(7)
    v_add_u32_sdwa v59, v192, v194 dst_sel:DWORD dst_unused:UNUSED_PAD src0_sel:BYTE_0 src1_sel:BYTE_0
    v_add_u32_sdwa v60, v193, v195 dst_sel:DWORD dst_unused:UNUSED_PAD src0_sel:BYTE_0 src1_sel:BYTE_0
    v_mfma_f32_32x32x16_bf16 v[96:111], v[168:171], a[208:211], v[96:111]
    buffer_load_dwordx4 v15, s[56:59], s83 offen offset:2048 lds
    v_add_u32_sdwa v59, v59, v196 dst_sel:DWORD dst_unused:UNUSED_PAD src0_sel:DWORD src1_sel:BYTE_0
    v_add_u32_sdwa v60, v60, v197 dst_sel:DWORD dst_unused:UNUSED_PAD src0_sel:DWORD src1_sel:BYTE_0
    s_waitcnt lgkmcnt(2)
    v_add_u32_sdwa v59, v59, v198 dst_sel:DWORD dst_unused:UNUSED_PAD src0_sel:DWORD src1_sel:BYTE_0
    v_add_u32_sdwa v60, v60, v199 dst_sel:DWORD dst_unused:UNUSED_PAD src0_sel:DWORD src1_sel:BYTE_0
    v_mfma_f32_32x32x16_bf16 v[112:127], v[168:171], a[212:215], v[112:127]
    buffer_load_dwordx4 v16, s[56:59], s83 offen offset:3072 lds
    v_add_u32_sdwa v59, v59, v200 dst_sel:DWORD dst_unused:UNUSED_PAD src0_sel:DWORD src1_sel:BYTE_0
    v_add_u32_sdwa v60, v60, v201 dst_sel:DWORD dst_unused:UNUSED_PAD src0_sel:DWORD src1_sel:BYTE_0
    v_add_u32_sdwa v59, v59, v202 dst_sel:DWORD dst_unused:UNUSED_PAD src0_sel:DWORD src1_sel:BYTE_0
    v_add_u32_sdwa v60, v60, v203 dst_sel:DWORD dst_unused:UNUSED_PAD src0_sel:DWORD src1_sel:BYTE_0
    v_mfma_f32_32x32x16_bf16 v[128:143], v[172:175], a[208:211], v[128:143]
    s_waitcnt lgkmcnt(0)
    v_add_u32_sdwa v59, v59, v204 dst_sel:DWORD dst_unused:UNUSED_PAD src0_sel:DWORD src1_sel:BYTE_0
    v_add_u32_sdwa v60, v60, v205 dst_sel:DWORD dst_unused:UNUSED_PAD src0_sel:DWORD src1_sel:BYTE_0
    v_add_u32_sdwa v59, v59, v206 dst_sel:DWORD dst_unused:UNUSED_PAD src0_sel:DWORD src1_sel:BYTE_0
    v_add_u32_sdwa v60, v60, v207 dst_sel:DWORD dst_unused:UNUSED_PAD src0_sel:DWORD src1_sel:BYTE_0
    v_add_u32 v59, v59, v60
    v_mfma_f32_32x32x16_bf16 v[144:159], v[172:175], a[212:215], v[144:159]
    v_cmp_ne_u32 vcc, v59, v58
    s_cbranch_vccnz L_rs
L_rs_back:
    v_and_b32 v207, 0xffffff00, v207
    v_and_b32 v206, 0xffffff00, v206
    v_mfma_f32_32x32x16_bf16 v[96:111], v[176:179], a[216:219], v[96:111]
    v_fmac_f32 v206, v232, v207
    v_and_b32 v205, 0xffffff00, v205
    v_fmac_f32_dpp v206, v207, v233 row_ror:8 row_mask:0xf bank_mask:0xf
    v_fmac_f32 v205, v232, v206
    v_and_b32 v204, 0xffffff00, v204
    v_mfma_f32_32x32x16_bf16 v[112:127], v[176:179], a[220:223], v[112:127]
    v_fmac_f32_dpp v205, v206, v233 row_ror:8 row_mask:0xf bank_mask:0xf
    v_fmac_f32 v204, v232, v205
    v_and_b32 v203, 0xffffff00, v203
    v_fmac_f32_dpp v204, v205, v233 row_ror:8 row_mask:0xf bank_mask:0xf
    v_fmac_f32 v203, v232, v204
    v_mfma_f32_32x32x16_bf16 v[128:143], v[180:183], a[216:219], v[128:143]
    v_and_b32 v202, 0xffffff00, v202
    v_fmac_f32_dpp v203, v204, v233 row_ror:8 row_mask:0xf bank_mask:0xf
    v_fmac_f32 v202, v232, v203
    v_and_b32 v201, 0xffffff00, v201
    v_fmac_f32_dpp v202, v203, v233 row_ror:8 row_mask:0xf bank_mask:0xf
    v_mfma_f32_32x32x16_bf16 v[144:159], v[180:183], a[220:223], v[144:159]
    v_fmac_f32 v201, v232, v202
    v_and_b32 v200, 0xffffff00, v200
    v_fmac_f32_dpp v201, v202, v233 row_ror:8 row_mask:0xf bank_mask:0xf
    v_fmac_f32 v200, v232, v201
    v_and_b32 v199, 0xffffff00, v199
    v_fmac_f32_dpp v200, v201, v233 row_ror:8 row_mask:0xf bank_mask:0xf
    v_fmac_f32 v199, v232, v200
    v_and_b32 v198, 0xffffff00, v198
    v_fmac_f32_dpp v199, v200, v233 row_ror:8 row_mask:0xf bank_mask:0xf
    v_fmac_f32 v198, v232, v199
    v_and_b32 v197, 0xffffff00, v197
    v_fmac_f32_dpp v198, v199, v233 row_ror:8 row_mask:0xf bank_mask:0xf
    v_fmac_f32 v197, v232, v198
    v_and_b32 v196, 0xffffff00, v196
    v_fmac_f32_dpp v197, v198, v233 row_ror:8 row_mask:0xf bank_mask:0xf
    v_fmac_f32 v196, v232, v197
    v_and_b32 v195, 0xffffff00, v195
    v_fmac_f32_dpp v196, v197, v233 row_ror:8 row_mask:0xf bank_mask:0xf
    v_fmac_f32 v195, v232, v196
    v_and_b32 v194, 0xffffff00, v194
    v_fmac_f32_dpp v195, v196, v233 row_ror:8 row_mask:0xf bank_mask:0xf
    v_fmac_f32 v194, v232, v195
    v_and_b32 v193, 0xffffff00, v193
    v_fmac_f32_dpp v194, v195, v233 row_ror:8 row_mask:0xf bank_mask:0xf
    v_fmac_f32 v193, v232, v194
    v_and_b32 v192, 0xffffff00, v192
    v_fmac_f32_dpp v193, v194, v233 row_ror:8 row_mask:0xf bank_mask:0xf
    v_fmac_f32 v192, v232, v193
    s_nop 0
    v_fmac_f32_dpp v192, v193, v233 row_ror:8 row_mask:0xf bank_mask:0xf
    v_mov_b32 v250, v192
    v_mov_b32 v251, v192
    s_nop 1
    v_permlane32_swap_b32 v250, v251
    ds_read_b128 v[192:195], v48 offset:0
    ds_read_b128 v[196:199], v48 offset:16
    v_fmac_f32 v250, v230, v251
    v_fmac_f32_dpp v250, v251, v231 row_ror:8 row_mask:0xf bank_mask:0xf
    ds_read_b128 v[200:203], v48 offset:32
    ds_read_b128 v[204:207], v48 offset:48
    v_fmac_f32 v240, v228, v250
    v_fmac_f32_dpp v240, v250, v229 row_ror:8 row_mask:0xf bank_mask:0xf
    v_fmac_f32 v238, v236, v250
    v_fmac_f32_dpp v238, v250, v237 row_ror:8 row_mask:0xf bank_mask:0xf
    ds_read_b128 v[208:211], v48 offset:128
    ds_read_b128 v[212:215], v48 offset:144
    v_fmac_f32 v239, v236, v240
    v_fmac_f32_dpp v239, v240, v237 row_ror:8 row_mask:0xf bank_mask:0xf
    ds_read_b128 v[216:219], v48 offset:160
    ds_read_b128 v[220:223], v48 offset:176
    v_fmac_f32 v64, v224, v238
    v_fmac_f32 v80, v224, v239
    v_fmac_f32_dpp v64, v238, v225 row_ror:8 row_mask:0xf bank_mask:0xf
    v_fmac_f32_dpp v80, v239, v225 row_ror:8 row_mask:0xf bank_mask:0xf
    v_fmac_f32 v65, v224, v64
    v_fmac_f32 v81, v224, v80
    v_fmac_f32_dpp v65, v64, v225 row_ror:8 row_mask:0xf bank_mask:0xf
    v_fmac_f32_dpp v81, v80, v225 row_ror:8 row_mask:0xf bank_mask:0xf
    v_fmac_f32 v66, v224, v65
    v_fmac_f32 v82, v224, v81
    v_fmac_f32_dpp v66, v65, v225 row_ror:8 row_mask:0xf bank_mask:0xf
    v_fmac_f32_dpp v82, v81, v225 row_ror:8 row_mask:0xf bank_mask:0xf
    v_fmac_f32 v67, v224, v66
    v_fmac_f32 v83, v224, v82
    v_fmac_f32_dpp v67, v66, v225 row_ror:8 row_mask:0xf bank_mask:0xf
    v_fmac_f32_dpp v83, v82, v225 row_ror:8 row_mask:0xf bank_mask:0xf
    v_fmac_f32 v68, v224, v67
    v_fmac_f32 v84, v224, v83
    v_fmac_f32_dpp v68, v67, v225 row_ror:8 row_mask:0xf bank_mask:0xf
    v_fmac_f32_dpp v84, v83, v225 row_ror:8 row_mask:0xf bank_mask:0xf
    v_fmac_f32 v69, v224, v68
    v_fmac_f32 v85, v224, v84
    v_fmac_f32_dpp v69, v68, v225 row_ror:8 row_mask:0xf bank_mask:0xf
    v_fmac_f32_dpp v85, v84, v225 row_ror:8 row_mask:0xf bank_mask:0xf
    v_fmac_f32 v70, v224, v69
    v_fmac_f32 v86, v224, v85
    v_fmac_f32_dpp v70, v69, v225 row_ror:8 row_mask:0xf bank_mask:0xf
    v_fmac_f32_dpp v86, v85, v225 row_ror:8 row_mask:0xf bank_mask:0xf
    v_fmac_f32 v71, v224, v70
    v_fmac_f32 v87, v224, v86
    v_fmac_f32_dpp v71, v70, v225 row_ror:8 row_mask:0xf bank_mask:0xf
    v_fmac_f32_dpp v87, v86, v225 row_ror:8 row_mask:0xf bank_mask:0xf
    v_fmac_f32 v72, v224, v71
    v_fmac_f32 v88, v224, v87
    v_fmac_f32_dpp v72, v71, v225 row_ror:8 row_mask:0xf bank_mask:0xf
    v_fmac_f32_dpp v88, v87, v225 row_ror:8 row_mask:0xf bank_mask:0xf
    v_fmac_f32 v73, v224, v72
    v_fmac_f32 v89, v224, v88
    v_fmac_f32_dpp v73, v72, v225 row_ror:8 row_mask:0xf bank_mask:0xf
    v_fmac_f32_dpp v89, v88, v225 row_ror:8 row_mask:0xf bank_mask:0xf
    v_fmac_f32 v74, v224, v73
    v_fmac_f32 v90, v224, v89
    v_fmac_f32_dpp v74, v73, v225 row_ror:8 row_mask:0xf bank_mask:0xf
    v_fmac_f32_dpp v90, v89, v225 row_ror:8 row_mask:0xf bank_mask:0xf
    v_fmac_f32 v75, v224, v74
    v_fmac_f32 v91, v224, v90
    v_fmac_f32_dpp v75, v74, v225 row_ror:8 row_mask:0xf bank_mask:0xf
    v_fmac_f32_dpp v91, v90, v225 row_ror:8 row_mask:0xf bank_mask:0xf
    v_fmac_f32 v76, v224, v75
    v_fmac_f32 v92, v224, v91
    v_fmac_f32_dpp v76, v75, v225 row_ror:8 row_mask:0xf bank_mask:0xf
    v_fmac_f32_dpp v92, v91, v225 row_ror:8 row_mask:0xf bank_mask:0xf
    v_fmac_f32 v77, v224, v76
    v_fmac_f32 v93, v224, v92
    v_fmac_f32_dpp v77, v76, v225 row_ror:8 row_mask:0xf bank_mask:0xf
    v_fmac_f32_dpp v93, v92, v225 row_ror:8 row_mask:0xf bank_mask:0xf
    v_fmac_f32 v78, v224, v77
    v_fmac_f32 v94, v224, v93
    v_fmac_f32_dpp v78, v77, v225 row_ror:8 row_mask:0xf bank_mask:0xf
    v_fmac_f32_dpp v94, v93, v225 row_ror:8 row_mask:0xf bank_mask:0xf
    v_fmac_f32 v79, v224, v78
    v_fmac_f32 v95, v224, v94
    v_fmac_f32_dpp v79, v78, v225 row_ror:8 row_mask:0xf bank_mask:0xf
    v_fmac_f32_dpp v95, v94, v225 row_ror:8 row_mask:0xf bank_mask:0xf
    s_waitcnt lgkmcnt(7)
    v_pk_mul_f32 v[192:193], v[64:65], v[192:193]
    v_pk_mul_f32 v[194:195], v[66:67], v[194:195]
    s_waitcnt lgkmcnt(6)
    v_pk_mul_f32 v[196:197], v[68:69], v[196:197]
    v_pk_mul_f32 v[198:199], v[70:71], v[198:199]
    s_waitcnt lgkmcnt(5)
    v_pk_mul_f32 v[200:201], v[72:73], v[200:201]
    v_pk_mul_f32 v[202:203], v[74:75], v[202:203]
    s_waitcnt lgkmcnt(4)
    v_pk_mul_f32 v[204:205], v[76:77], v[204:205]
    v_pk_mul_f32 v[206:207], v[78:79], v[206:207]
    v_cvt_pk_bf16_f32 v192, v192, v193
    v_cvt_pk_bf16_f32 v193, v194, v195
    v_cvt_pk_bf16_f32 v194, v196, v197
    v_cvt_pk_bf16_f32 v195, v198, v199
    v_cvt_pk_bf16_f32 v196, v200, v201
    v_cvt_pk_bf16_f32 v197, v202, v203
    v_cvt_pk_bf16_f32 v198, v204, v205
    v_cvt_pk_bf16_f32 v199, v206, v207
    ds_write_b128 v40, v[192:195]
    v_xor_b32 v62, 16, v40
    ds_write_b128 v62, v[196:199]
    s_waitcnt lgkmcnt(5)
    v_pk_mul_f32 v[208:209], v[80:81], v[208:209]
    v_pk_mul_f32 v[210:211], v[82:83], v[210:211]
    s_waitcnt lgkmcnt(4)
    v_pk_mul_f32 v[212:213], v[84:85], v[212:213]
    v_pk_mul_f32 v[214:215], v[86:87], v[214:215]
    s_waitcnt lgkmcnt(3)
    v_pk_mul_f32 v[216:217], v[88:89], v[216:217]
    v_pk_mul_f32 v[218:219], v[90:91], v[218:219]
    s_waitcnt lgkmcnt(2)
    v_pk_mul_f32 v[220:221], v[92:93], v[220:221]
    v_pk_mul_f32 v[222:223], v[94:95], v[222:223]
    v_cvt_pk_bf16_f32 v208, v208, v209
    v_cvt_pk_bf16_f32 v209, v210, v211
    v_cvt_pk_bf16_f32 v210, v212, v213
    v_cvt_pk_bf16_f32 v211, v214, v215
    v_cvt_pk_bf16_f32 v212, v216, v217
    v_cvt_pk_bf16_f32 v213, v218, v219
    v_cvt_pk_bf16_f32 v214, v220, v221
    v_cvt_pk_bf16_f32 v215, v222, v223
    v_xor_b32 v61, 64, v40
    ds_write_b128 v61, v[208:211]
    v_xor_b32 v62, 80, v40
    ds_write_b128 v62, v[212:215]
    .p2align 3
    v_pk_mul_f32 v[242:243], v[96:97], v[96:97]
    v_pk_mul_f32 v[244:245], v[98:99], v[98:99]
    v_pk_mul_f32 v[246:247], v[100:101], v[100:101]
    v_pk_mul_f32 v[248:249], v[102:103], v[102:103]
    v_pk_fma_f32 v[242:243], v[242:243], v[52:53], v[52:53] op_sel:[0,0,1] op_sel_hi:[1,0,1]
    v_pk_fma_f32 v[244:245], v[244:245], v[52:53], v[52:53] op_sel:[0,0,1] op_sel_hi:[1,0,1]
    s_add_u32 m0, s79, 8192
    v_pk_fma_f32 v[246:247], v[246:247], v[52:53], v[52:53] op_sel:[0,0,1] op_sel_hi:[1,0,1]
    v_pk_fma_f32 v[248:249], v[248:249], v[52:53], v[52:53] op_sel:[0,0,1] op_sel_hi:[1,0,1]
    v_pk_mul_f32 v[242:243], v[96:97], v[242:243]
    v_pk_mul_f32 v[244:245], v[98:99], v[244:245]
    v_pk_mul_f32 v[246:247], v[100:101], v[246:247]
    v_pk_mul_f32 v[248:249], v[102:103], v[248:249]
    s_add_u32 s83, s83, 114688
    v_exp_f32 v242, v242
    v_exp_f32 v243, v243
    v_exp_f32 v244, v244
    v_exp_f32 v245, v245
    v_exp_f32 v246, v246
    v_exp_f32 v247, v247
    buffer_load_dwordx4 v13, s[56:59], s83 offen offset:0 lds
    v_exp_f32 v248, v248
    v_exp_f32 v249, v249
    v_pk_fma_f32 v[242:243], v[242:243], v[54:55], v[54:55] op_sel:[0,0,0] op_sel_hi:[1,0,0]
    v_pk_fma_f32 v[244:245], v[244:245], v[54:55], v[54:55] op_sel:[0,0,0] op_sel_hi:[1,0,0]
    v_pk_fma_f32 v[246:247], v[246:247], v[54:55], v[54:55] op_sel:[0,0,0] op_sel_hi:[1,0,0]
    v_pk_fma_f32 v[248:249], v[248:249], v[54:55], v[54:55] op_sel:[0,0,0] op_sel_hi:[1,0,0]
    buffer_load_dwordx4 v14, s[56:59], s83 offen offset:1024 lds
    v_rcp_f32 v242, v242
    v_pk_mul_f32 v[168:169], v[112:113], v[112:113]
    v_rcp_f32 v243, v243
    v_pk_mul_f32 v[170:171], v[114:115], v[114:115]
    v_rcp_f32 v244, v244
    v_pk_mul_f32 v[172:173], v[116:117], v[116:117]
    buffer_load_dwordx4 v15, s[56:59], s83 offen offset:2048 lds
    v_rcp_f32 v245, v245
    v_pk_mul_f32 v[174:175], v[118:119], v[118:119]
    v_rcp_f32 v246, v246
    v_pk_fma_f32 v[168:169], v[168:169], v[52:53], v[52:53] op_sel:[0,0,1] op_sel_hi:[1,0,1]
    v_rcp_f32 v247, v247
    v_pk_fma_f32 v[170:171], v[170:171], v[52:53], v[52:53] op_sel:[0,0,1] op_sel_hi:[1,0,1]
    buffer_load_dwordx4 v16, s[56:59], s83 offen offset:3072 lds
    v_rcp_f32 v248, v248
    v_pk_fma_f32 v[172:173], v[172:173], v[52:53], v[52:53] op_sel:[0,0,1] op_sel_hi:[1,0,1]
    v_rcp_f32 v249, v249
    v_pk_fma_f32 v[174:175], v[174:175], v[52:53], v[52:53] op_sel:[0,0,1] op_sel_hi:[1,0,1]
    v_pk_mul_f32 v[168:169], v[112:113], v[168:169]
    v_pk_mul_f32 v[170:171], v[114:115], v[170:171]
    v_pk_mul_f32 v[172:173], v[116:117], v[172:173]
    v_pk_mul_f32 v[174:175], v[118:119], v[174:175]
    v_exp_f32 v168, v168
    v_pk_mul_f32 v[242:243], v[96:97], v[242:243]
    v_exp_f32 v169, v169
    v_pk_mul_f32 v[244:245], v[98:99], v[244:245]
    v_exp_f32 v170, v170
    v_pk_mul_f32 v[246:247], v[100:101], v[246:247]
    v_exp_f32 v171, v171
    v_pk_mul_f32 v[248:249], v[102:103], v[248:249]
    v_exp_f32 v172, v172
    v_cvt_pk_bf16_f32 v160, v242, v243
    v_exp_f32 v173, v173
    v_cvt_pk_bf16_f32 v161, v244, v245
    v_exp_f32 v174, v174
    v_cvt_pk_bf16_f32 v162, v246, v247
    v_exp_f32 v175, v175
    v_cvt_pk_bf16_f32 v163, v248, v249
    ds_write_b128 v38, v[160:163] offset:0
    v_pk_fma_f32 v[168:169], v[168:169], v[54:55], v[54:55] op_sel:[0,1,1] op_sel_hi:[1,1,1]
    v_pk_fma_f32 v[170:171], v[170:171], v[54:55], v[54:55] op_sel:[0,1,1] op_sel_hi:[1,1,1]
    v_pk_fma_f32 v[172:173], v[172:173], v[54:55], v[54:55] op_sel:[0,1,1] op_sel_hi:[1,1,1]
    v_pk_fma_f32 v[174:175], v[174:175], v[54:55], v[54:55] op_sel:[0,1,1] op_sel_hi:[1,1,1]
    v_rcp_f32 v168, v168
    v_pk_mul_f32 v[242:243], v[104:105], v[104:105]
    v_rcp_f32 v169, v169
    v_pk_mul_f32 v[244:245], v[106:107], v[106:107]
    v_rcp_f32 v170, v170
    v_pk_mul_f32 v[246:247], v[108:109], v[108:109]
    v_rcp_f32 v171, v171
    v_pk_mul_f32 v[248:249], v[110:111], v[110:111]
    v_rcp_f32 v172, v172
    v_pk_fma_f32 v[242:243], v[242:243], v[52:53], v[52:53] op_sel:[0,0,1] op_sel_hi:[1,0,1]
    v_rcp_f32 v173, v173
    v_pk_fma_f32 v[244:245], v[244:245], v[52:53], v[52:53] op_sel:[0,0,1] op_sel_hi:[1,0,1]
    v_rcp_f32 v174, v174
    v_pk_fma_f32 v[246:247], v[246:247], v[52:53], v[52:53] op_sel:[0,0,1] op_sel_hi:[1,0,1]
    v_rcp_f32 v175, v175
    v_pk_fma_f32 v[248:249], v[248:249], v[52:53], v[52:53] op_sel:[0,0,1] op_sel_hi:[1,0,1]
    v_pk_mul_f32 v[242:243], v[104:105], v[242:243]
    v_pk_mul_f32 v[244:245], v[106:107], v[244:245]
    v_pk_mul_f32 v[246:247], v[108:109], v[246:247]
    v_pk_mul_f32 v[248:249], v[110:111], v[248:249]
    v_exp_f32 v242, v242
    v_pk_mul_f32 v[168:169], v[112:113], v[168:169]
    v_exp_f32 v243, v243
    v_pk_mul_f32 v[170:171], v[114:115], v[170:171]
    v_exp_f32 v244, v244
    v_pk_mul_f32 v[172:173], v[116:117], v[172:173]
    v_exp_f32 v245, v245
    v_pk_mul_f32 v[174:175], v[118:119], v[174:175]
    v_exp_f32 v246, v246
    v_cvt_pk_bf16_f32 v164, v168, v169
    v_exp_f32 v247, v247
    v_cvt_pk_bf16_f32 v165, v170, v171
    v_exp_f32 v248, v248
    v_cvt_pk_bf16_f32 v166, v172, v173
    v_exp_f32 v249, v249
    v_cvt_pk_bf16_f32 v167, v174, v175
    ds_write_b128 v38, v[164:167] offset:1024
    v_pk_fma_f32 v[242:243], v[242:243], v[54:55], v[54:55] op_sel:[0,0,0] op_sel_hi:[1,0,0]
    v_pk_fma_f32 v[244:245], v[244:245], v[54:55], v[54:55] op_sel:[0,0,0] op_sel_hi:[1,0,0]
    v_pk_fma_f32 v[246:247], v[246:247], v[54:55], v[54:55] op_sel:[0,0,0] op_sel_hi:[1,0,0]
    v_pk_fma_f32 v[248:249], v[248:249], v[54:55], v[54:55] op_sel:[0,0,0] op_sel_hi:[1,0,0]
    v_rcp_f32 v242, v242
    v_pk_mul_f32 v[168:169], v[120:121], v[120:121]
    v_rcp_f32 v243, v243
    v_pk_mul_f32 v[170:171], v[122:123], v[122:123]
    v_rcp_f32 v244, v244
    v_pk_mul_f32 v[172:173], v[124:125], v[124:125]
    v_rcp_f32 v245, v245
    v_pk_mul_f32 v[174:175], v[126:127], v[126:127]
    v_rcp_f32 v246, v246
    v_pk_fma_f32 v[168:169], v[168:169], v[52:53], v[52:53] op_sel:[0,0,1] op_sel_hi:[1,0,1]
    v_rcp_f32 v247, v247
    v_pk_fma_f32 v[170:171], v[170:171], v[52:53], v[52:53] op_sel:[0,0,1] op_sel_hi:[1,0,1]
    v_rcp_f32 v248, v248
    v_pk_fma_f32 v[172:173], v[172:173], v[52:53], v[52:53] op_sel:[0,0,1] op_sel_hi:[1,0,1]
    v_rcp_f32 v249, v249
    v_pk_fma_f32 v[174:175], v[174:175], v[52:53], v[52:53] op_sel:[0,0,1] op_sel_hi:[1,0,1]
    v_pk_mul_f32 v[168:169], v[120:121], v[168:169]
    v_pk_mul_f32 v[170:171], v[122:123], v[170:171]
    v_pk_mul_f32 v[172:173], v[124:125], v[172:173]
    v_pk_mul_f32 v[174:175], v[126:127], v[174:175]
    v_exp_f32 v168, v168
    v_pk_mul_f32 v[242:243], v[104:105], v[242:243]
    v_exp_f32 v169, v169
    v_pk_mul_f32 v[244:245], v[106:107], v[244:245]
    v_exp_f32 v170, v170
    v_pk_mul_f32 v[246:247], v[108:109], v[246:247]
    v_exp_f32 v171, v171
    v_pk_mul_f32 v[248:249], v[110:111], v[248:249]
    v_exp_f32 v172, v172
    v_cvt_pk_bf16_f32 v160, v242, v243
    v_exp_f32 v173, v173
    v_cvt_pk_bf16_f32 v161, v244, v245
    v_exp_f32 v174, v174
    v_cvt_pk_bf16_f32 v162, v246, v247
    v_exp_f32 v175, v175
    v_cvt_pk_bf16_f32 v163, v248, v249
    ds_write_b128 v38, v[160:163] offset:2048
    v_pk_fma_f32 v[168:169], v[168:169], v[54:55], v[54:55] op_sel:[0,1,1] op_sel_hi:[1,1,1]
    v_pk_fma_f32 v[170:171], v[170:171], v[54:55], v[54:55] op_sel:[0,1,1] op_sel_hi:[1,1,1]
    v_pk_fma_f32 v[172:173], v[172:173], v[54:55], v[54:55] op_sel:[0,1,1] op_sel_hi:[1,1,1]
    v_pk_fma_f32 v[174:175], v[174:175], v[54:55], v[54:55] op_sel:[0,1,1] op_sel_hi:[1,1,1]
    v_rcp_f32 v168, v168
    v_pk_mul_f32 v[242:243], v[128:129], v[128:129]
    v_rcp_f32 v169, v169
    v_pk_mul_f32 v[244:245], v[130:131], v[130:131]
    v_rcp_f32 v170, v170
    v_pk_mul_f32 v[246:247], v[132:133], v[132:133]
    v_rcp_f32 v171, v171
    v_pk_mul_f32 v[248:249], v[134:135], v[134:135]
    v_rcp_f32 v172, v172
    v_pk_fma_f32 v[242:243], v[242:243], v[52:53], v[52:53] op_sel:[0,0,1] op_sel_hi:[1,0,1]
    v_rcp_f32 v173, v173
    v_pk_fma_f32 v[244:245], v[244:245], v[52:53], v[52:53] op_sel:[0,0,1] op_sel_hi:[1,0,1]
    v_rcp_f32 v174, v174
    v_pk_fma_f32 v[246:247], v[246:247], v[52:53], v[52:53] op_sel:[0,0,1] op_sel_hi:[1,0,1]
    v_rcp_f32 v175, v175
    v_pk_fma_f32 v[248:249], v[248:249], v[52:53], v[52:53] op_sel:[0,0,1] op_sel_hi:[1,0,1]
    v_pk_mul_f32 v[242:243], v[128:129], v[242:243]
    v_pk_mul_f32 v[244:245], v[130:131], v[244:245]
    v_pk_mul_f32 v[246:247], v[132:133], v[246:247]
    v_pk_mul_f32 v[248:249], v[134:135], v[248:249]
    v_exp_f32 v242, v242
    v_pk_mul_f32 v[168:169], v[120:121], v[168:169]
    v_exp_f32 v243, v243
    v_pk_mul_f32 v[170:171], v[122:123], v[170:171]
    v_exp_f32 v244, v244
    v_pk_mul_f32 v[172:173], v[124:125], v[172:173]
    v_exp_f32 v245, v245
    v_pk_mul_f32 v[174:175], v[126:127], v[174:175]
    v_exp_f32 v246, v246
    v_cvt_pk_bf16_f32 v164, v168, v169
    v_exp_f32 v247, v247
    v_cvt_pk_bf16_f32 v165, v170, v171
    v_exp_f32 v248, v248
    v_cvt_pk_bf16_f32 v166, v172, v173
    v_exp_f32 v249, v249
    v_cvt_pk_bf16_f32 v167, v174, v175
    ds_write_b128 v38, v[164:167] offset:3072
    v_pk_fma_f32 v[242:243], v[242:243], v[54:55], v[54:55] op_sel:[0,0,0] op_sel_hi:[1,0,0]
    v_pk_fma_f32 v[244:245], v[244:245], v[54:55], v[54:55] op_sel:[0,0,0] op_sel_hi:[1,0,0]
    v_pk_fma_f32 v[246:247], v[246:247], v[54:55], v[54:55] op_sel:[0,0,0] op_sel_hi:[1,0,0]
    v_pk_fma_f32 v[248:249], v[248:249], v[54:55], v[54:55] op_sel:[0,0,0] op_sel_hi:[1,0,0]
    v_rcp_f32 v242, v242
    v_pk_mul_f32 v[168:169], v[144:145], v[144:145]
    v_rcp_f32 v243, v243
    v_pk_mul_f32 v[170:171], v[146:147], v[146:147]
    v_rcp_f32 v244, v244
    v_pk_mul_f32 v[172:173], v[148:149], v[148:149]
    v_rcp_f32 v245, v245
    v_pk_mul_f32 v[174:175], v[150:151], v[150:151]
    v_rcp_f32 v246, v246
    v_pk_fma_f32 v[168:169], v[168:169], v[52:53], v[52:53] op_sel:[0,0,1] op_sel_hi:[1,0,1]
    v_rcp_f32 v247, v247
    v_pk_fma_f32 v[170:171], v[170:171], v[52:53], v[52:53] op_sel:[0,0,1] op_sel_hi:[1,0,1]
    v_rcp_f32 v248, v248
    v_pk_fma_f32 v[172:173], v[172:173], v[52:53], v[52:53] op_sel:[0,0,1] op_sel_hi:[1,0,1]
    v_rcp_f32 v249, v249
    v_pk_fma_f32 v[174:175], v[174:175], v[52:53], v[52:53] op_sel:[0,0,1] op_sel_hi:[1,0,1]
    v_pk_mul_f32 v[168:169], v[144:145], v[168:169]
    v_pk_mul_f32 v[170:171], v[146:147], v[170:171]
    v_pk_mul_f32 v[172:173], v[148:149], v[172:173]
    v_pk_mul_f32 v[174:175], v[150:151], v[174:175]
    v_exp_f32 v168, v168
    v_pk_mul_f32 v[242:243], v[128:129], v[242:243]
    v_exp_f32 v169, v169
    v_pk_mul_f32 v[244:245], v[130:131], v[244:245]
    v_exp_f32 v170, v170
    v_pk_mul_f32 v[246:247], v[132:133], v[246:247]
    v_exp_f32 v171, v171
    v_pk_mul_f32 v[248:249], v[134:135], v[248:249]
    v_exp_f32 v172, v172
    v_cvt_pk_bf16_f32 v160, v242, v243
    v_exp_f32 v173, v173
    v_cvt_pk_bf16_f32 v161, v244, v245
    v_exp_f32 v174, v174
    v_cvt_pk_bf16_f32 v162, v246, v247
    v_exp_f32 v175, v175
    v_cvt_pk_bf16_f32 v163, v248, v249
    ds_write_b128 v38, v[160:163] offset:4096
    v_pk_fma_f32 v[168:169], v[168:169], v[54:55], v[54:55] op_sel:[0,1,1] op_sel_hi:[1,1,1]
    v_pk_fma_f32 v[170:171], v[170:171], v[54:55], v[54:55] op_sel:[0,1,1] op_sel_hi:[1,1,1]
    v_pk_fma_f32 v[172:173], v[172:173], v[54:55], v[54:55] op_sel:[0,1,1] op_sel_hi:[1,1,1]
    v_pk_fma_f32 v[174:175], v[174:175], v[54:55], v[54:55] op_sel:[0,1,1] op_sel_hi:[1,1,1]
    v_rcp_f32 v168, v168
    v_pk_mul_f32 v[242:243], v[136:137], v[136:137]
    v_rcp_f32 v169, v169
    v_pk_mul_f32 v[244:245], v[138:139], v[138:139]
    v_rcp_f32 v170, v170
    v_pk_mul_f32 v[246:247], v[140:141], v[140:141]
    v_rcp_f32 v171, v171
    v_pk_mul_f32 v[248:249], v[142:143], v[142:143]
    v_rcp_f32 v172, v172
    v_pk_fma_f32 v[242:243], v[242:243], v[52:53], v[52:53] op_sel:[0,0,1] op_sel_hi:[1,0,1]
    v_rcp_f32 v173, v173
    v_pk_fma_f32 v[244:245], v[244:245], v[52:53], v[52:53] op_sel:[0,0,1] op_sel_hi:[1,0,1]
    v_rcp_f32 v174, v174
    v_pk_fma_f32 v[246:247], v[246:247], v[52:53], v[52:53] op_sel:[0,0,1] op_sel_hi:[1,0,1]
    v_rcp_f32 v175, v175
    v_pk_fma_f32 v[248:249], v[248:249], v[52:53], v[52:53] op_sel:[0,0,1] op_sel_hi:[1,0,1]
    v_pk_mul_f32 v[242:243], v[136:137], v[242:243]
    v_pk_mul_f32 v[244:245], v[138:139], v[244:245]
    v_pk_mul_f32 v[246:247], v[140:141], v[246:247]
    v_pk_mul_f32 v[248:249], v[142:143], v[248:249]
    v_exp_f32 v242, v242
    v_pk_mul_f32 v[168:169], v[144:145], v[168:169]
    v_exp_f32 v243, v243
    v_pk_mul_f32 v[170:171], v[146:147], v[170:171]
    v_exp_f32 v244, v244
    v_pk_mul_f32 v[172:173], v[148:149], v[172:173]
    v_exp_f32 v245, v245
    v_pk_mul_f32 v[174:175], v[150:151], v[174:175]
    v_exp_f32 v246, v246
    v_cvt_pk_bf16_f32 v164, v168, v169
    v_exp_f32 v247, v247
    v_cvt_pk_bf16_f32 v165, v170, v171
    v_exp_f32 v248, v248
    v_cvt_pk_bf16_f32 v166, v172, v173
    v_exp_f32 v249, v249
    v_cvt_pk_bf16_f32 v167, v174, v175
    ds_write_b128 v38, v[164:167] offset:5120
    v_pk_fma_f32 v[242:243], v[242:243], v[54:55], v[54:55] op_sel:[0,0,0] op_sel_hi:[1,0,0]
    v_pk_fma_f32 v[244:245], v[244:245], v[54:55], v[54:55] op_sel:[0,0,0] op_sel_hi:[1,0,0]
    v_pk_fma_f32 v[246:247], v[246:247], v[54:55], v[54:55] op_sel:[0,0,0] op_sel_hi:[1,0,0]
    v_pk_fma_f32 v[248:249], v[248:249], v[54:55], v[54:55] op_sel:[0,0,0] op_sel_hi:[1,0,0]
    v_rcp_f32 v242, v242
    v_pk_mul_f32 v[168:169], v[152:153], v[152:153]
    v_rcp_f32 v243, v243
    v_pk_mul_f32 v[170:171], v[154:155], v[154:155]
    v_rcp_f32 v244, v244
    v_pk_mul_f32 v[172:173], v[156:157], v[156:157]
    v_rcp_f32 v245, v245
    v_pk_mul_f32 v[174:175], v[158:159], v[158:159]
    v_rcp_f32 v246, v246
    v_pk_fma_f32 v[168:169], v[168:169], v[52:53], v[52:53] op_sel:[0,0,1] op_sel_hi:[1,0,1]
    v_rcp_f32 v247, v247
    v_pk_fma_f32 v[170:171], v[170:171], v[52:53], v[52:53] op_sel:[0,0,1] op_sel_hi:[1,0,1]
    v_rcp_f32 v248, v248
    v_pk_fma_f32 v[172:173], v[172:173], v[52:53], v[52:53] op_sel:[0,0,1] op_sel_hi:[1,0,1]
    v_rcp_f32 v249, v249
    v_pk_fma_f32 v[174:175], v[174:175], v[52:53], v[52:53] op_sel:[0,0,1] op_sel_hi:[1,0,1]
    v_pk_mul_f32 v[168:169], v[152:153], v[168:169]
    v_pk_mul_f32 v[170:171], v[154:155], v[170:171]
    v_pk_mul_f32 v[172:173], v[156:157], v[172:173]
    v_pk_mul_f32 v[174:175], v[158:159], v[174:175]
    v_exp_f32 v168, v168
    v_pk_mul_f32 v[242:243], v[136:137], v[242:243]
    v_exp_f32 v169, v169
    v_pk_mul_f32 v[244:245], v[138:139], v[244:245]
    v_exp_f32 v170, v170
    v_pk_mul_f32 v[246:247], v[140:141], v[246:247]
    v_exp_f32 v171, v171
    v_pk_mul_f32 v[248:249], v[142:143], v[248:249]
    v_exp_f32 v172, v172
    v_cvt_pk_bf16_f32 v160, v242, v243
    v_exp_f32 v173, v173
    v_cvt_pk_bf16_f32 v161, v244, v245
    v_exp_f32 v174, v174
    v_cvt_pk_bf16_f32 v162, v246, v247
    v_exp_f32 v175, v175
    v_cvt_pk_bf16_f32 v163, v248, v249
    ds_write_b128 v38, v[160:163] offset:6144
    v_pk_fma_f32 v[168:169], v[168:169], v[54:55], v[54:55] op_sel:[0,1,1] op_sel_hi:[1,1,1]
    v_pk_fma_f32 v[170:171], v[170:171], v[54:55], v[54:55] op_sel:[0,1,1] op_sel_hi:[1,1,1]
    v_pk_fma_f32 v[172:173], v[172:173], v[54:55], v[54:55] op_sel:[0,1,1] op_sel_hi:[1,1,1]
    v_pk_fma_f32 v[174:175], v[174:175], v[54:55], v[54:55] op_sel:[0,1,1] op_sel_hi:[1,1,1]
    v_rcp_f32 v168, v168
    v_rcp_f32 v169, v169
    v_rcp_f32 v170, v170
    v_rcp_f32 v171, v171
    v_rcp_f32 v172, v172
    v_rcp_f32 v173, v173
    v_rcp_f32 v174, v174
    v_rcp_f32 v175, v175
    v_pk_mul_f32 v[168:169], v[152:153], v[168:169]
    v_pk_mul_f32 v[170:171], v[154:155], v[170:171]
    v_pk_mul_f32 v[172:173], v[156:157], v[172:173]
    v_pk_mul_f32 v[174:175], v[158:159], v[174:175]
    v_cvt_pk_bf16_f32 v164, v168, v169
    v_cvt_pk_bf16_f32 v165, v170, v171
    v_cvt_pk_bf16_f32 v166, v172, v173
    v_cvt_pk_bf16_f32 v167, v174, v175
    ds_write_b128 v38, v[164:167] offset:7168
    s_waitcnt lgkmcnt(0)
    s_barrier
    ds_read_b64_tr_b16 a[0:1], v37 offset:0
    ds_read_b64_tr_b16 a[2:3], v37 offset:512
    ds_read_b128 a[96:99], v29 offset:12288
    ds_read_b64_tr_b16 a[4:5], v37 offset:2048
    ds_read_b64_tr_b16 a[6:7], v37 offset:2560
    ds_read_b128 a[100:103], v30 offset:12288
    ds_read_b64_tr_b16 a[8:9], v37 offset:4096
    ds_read_b64_tr_b16 a[10:11], v37 offset:4608
    ds_read_b128 a[104:107], v31 offset:12288
    v_mov_b32 v160, 0xfffefffe
    s_waitcnt lgkmcnt(6)
    v_mfma_f32_32x32x16_bf16 v[96:111], a[96:99], a[0:3], 0
    ds_read_b64_tr_b16 a[12:13], v37 offset:6144
    ds_read_b64_tr_b16 a[14:15], v37 offset:6656
    ds_read_b128 a[108:111], v32 offset:12288
    s_waitcnt lgkmcnt(6)
    v_mfma_f32_32x32x16_bf16 v[96:111], a[100:103], a[4:7], v[96:111]
    ds_read_b64_tr_b16 a[16:17], v37 offset:8192
    ds_read_b64_tr_b16 a[18:19], v37 offset:8704
    ds_read_b128 a[112:115], v33 offset:12288
    s_waitcnt lgkmcnt(6)
    v_mfma_f32_32x32x16_bf16 v[96:111], a[104:107], a[8:11], v[96:111]
    ds_read_b64_tr_b16 a[20:21], v37 offset:10240
    ds_read_b64_tr_b16 a[22:23], v37 offset:10752
    ds_read_b128 a[116:119], v34 offset:12288
    ds_read_b128 a[32:35], v39 offset:0
    ds_read_b128 a[36:39], v39 offset:2048
    s_waitcnt lgkmcnt(8)
    v_mfma_f32_32x32x16_bf16 v[96:111], a[108:111], a[12:15], v[96:111]
    ds_read_b64_tr_b16 a[24:25], v37 offset:12288
    ds_read_b64_tr_b16 a[26:27], v37 offset:12800
    ds_read_b128 a[120:123], v35 offset:12288
    ds_read_b128 a[40:43], v39 offset:4096
    ds_read_b128 a[44:47], v39 offset:6144
    s_waitcnt lgkmcnt(10)
    v_mfma_f32_32x32x16_bf16 v[96:111], a[112:115], a[16:19], v[96:111]
    ds_read_b64_tr_b16 a[28:29], v37 offset:14336
    ds_read_b64_tr_b16 a[30:31], v37 offset:14848
    ds_read_b128 a[124:127], v36 offset:12288
    ds_read_b128 a[48:51], v39 offset:8192
    ds_read_b128 a[52:55], v39 offset:10240
    s_waitcnt lgkmcnt(10)
    v_mfma_f32_32x32x16_bf16 v[96:111], a[116:119], a[20:23], v[96:111]
    ds_read_b128 a[56:59], v39 offset:12288
    ds_read_b128 a[60:63], v39 offset:14336
    s_waitcnt lgkmcnt(4)
    s_barrier
    ds_read_b64_tr_b16 a[128:129], v27 offset:16384
    ds_read_b64_tr_b16 a[130:131], v27 offset:16896
    ds_read_b64_tr_b16 a[132:133], v27 offset:17408
    s_add_u32 m0, s79, 12288
    s_bfe_u32 s83, s0, 0x30006
    s_mul_i32 s83, s83, 57344
    s_add_u32 s83, s83, s87
    buffer_load_dwordx4 v2, s[60:63], s83 offen offset:0 lds
    v_mfma_f32_32x32x16_bf16 v[96:111], a[120:123], a[24:27], v[96:111]
    ds_read_b64_tr_b16 a[134:135], v27 offset:17920
    ds_read_b64_tr_b16 a[136:137], v27 offset:40960
    ds_read_b64_tr_b16 a[138:139], v27 offset:41472
    v_mfma_f32_32x32x16_bf16 v[96:111], a[124:127], a[28:31], v[96:111]
    ds_read_b64_tr_b16 a[140:141], v27 offset:41984
    ds_read_b64_tr_b16 a[142:143], v27 offset:42496
    ds_read_b64_tr_b16 a[144:145], v28 offset:16384
    buffer_load_dwordx4 v3, s[60:63], s83 offen offset:1024 lds
    s_waitcnt lgkmcnt(6)
    v_mfma_f32_32x32x16_bf16 v[96:111], a[128:131], a[32:35], v[96:111]
    ds_read_b128 a[64:67], v39 offset:16384
    ds_read_b64_tr_b16 a[146:147], v28 offset:16896
    ds_read_b64_tr_b16 a[148:149], v28 offset:17408
    ds_read_b64_tr_b16 a[150:151], v28 offset:17920
    v_bfe_u32 v161, v255, 0, 1
    s_waitcnt lgkmcnt(7)
    v_mfma_f32_32x32x16_bf16 v[96:111], a[132:135], a[36:39], v[96:111]
    ds_read_b128 a[68:71], v39 offset:18432
    ds_read_b64_tr_b16 a[152:153], v28 offset:40960
    ds_read_b64_tr_b16 a[154:155], v28 offset:41472
    ds_read_b64_tr_b16 a[156:157], v28 offset:41984
    buffer_load_dwordx4 v7, s[60:63], s83 offen offset:2048 lds
    v_mfma_f32_32x32x16_bf16 v[96:111], a[136:139], a[40:43], v[96:111]
    ds_read_b128 a[72:75], v39 offset:20480
    ds_read_b64_tr_b16 a[158:159], v28 offset:42496
    v_bfe_u32 v59, v255, 1, 1
    v_lshl_or_b32 v161, v59, 16, v161
    v_bfe_u32 v162, v255, 2, 1
    s_waitcnt lgkmcnt(6)
    v_mfma_f32_32x32x16_bf16 v[96:111], a[140:143], a[44:47], v[96:111]
    ds_read_b128 a[76:79], v39 offset:22528
    buffer_load_dwordx4 v8, s[60:63], s83 offen offset:3072 lds
    s_waitcnt vmcnt(16) lgkmcnt(1)
    s_barrier
    ds_read_b64_tr_b16 a[160:161], v27 offset:20480
    ds_read_b64_tr_b16 a[162:163], v27 offset:20992
    ds_read_b64_tr_b16 a[164:165], v27 offset:21504
    s_add_u32 m0, s79, 16384
    s_bfe_u32 s83, s0, 0x30006
    s_lshl_b32 s83, s83, 7
    s_add_u32 s83, s83, s86
    buffer_load_dwordx4 v13, s[56:59], s83 offen offset:0 lds
    v_mfma_f32_32x32x16_bf16 v[96:111], a[144:147], a[48:51], v[96:111]
    ds_read_b128 a[80:83], v39 offset:24576
    ds_read_b64_tr_b16 a[166:167], v27 offset:22016
    ds_read_b64_tr_b16 a[168:169], v27 offset:45056
    ds_read_b64_tr_b16 a[170:171], v27 offset:45568
    v_bfe_u32 v59, v255, 3, 1
    v_mfma_f32_32x32x16_bf16 v[96:111], a[148:151], a[52:55], v[96:111]
    ds_read_b128 a[84:87], v39 offset:26624
    ds_read_b64_tr_b16 a[172:173], v27 offset:46080
    ds_read_b64_tr_b16 a[174:175], v27 offset:46592
    ds_read_b64_tr_b16 a[176:177], v28 offset:20480
    buffer_load_dwordx4 v14, s[56:59], s83 offen offset:1024 lds
    v_mfma_f32_32x32x16_bf16 v[96:111], a[152:155], a[56:59], v[96:111]
    ds_read_b128 a[88:91], v39 offset:28672
    ds_read_b64_tr_b16 a[178:179], v28 offset:20992
    ds_read_b64_tr_b16 a[180:181], v28 offset:21504
    ds_read_b64_tr_b16 a[182:183], v28 offset:22016
    v_lshl_or_b32 v162, v59, 16, v162
    v_mfma_f32_32x32x16_bf16 v[96:111], a[156:159], a[60:63], v[96:111]
    ds_read_b128 a[92:95], v39 offset:30720
    ds_read_b64_tr_b16 a[184:185], v28 offset:45056
    ds_read_b64_tr_b16 a[186:187], v28 offset:45568
    ds_read_b64_tr_b16 a[188:189], v28 offset:46080
    buffer_load_dwordx4 v15, s[56:59], s83 offen offset:2048 lds
    s_waitcnt lgkmcnt(8)
    v_mfma_f32_32x32x16_bf16 v[96:111], a[160:163], a[64:67], v[96:111]
    ds_read_b64_tr_b16 a[190:191], v28 offset:46592
    v_bfe_u32 v163, v255, 4, 1
    v_bfe_u32 v59, v255, 5, 1
    v_lshl_or_b32 v163, v59, 16, v163
    v_bfe_u32 v180, v255, 6, 1
    v_mfma_f32_32x32x16_bf16 v[96:111], a[164:167], a[68:71], v[96:111]
    buffer_load_dwordx4 v16, s[56:59], s83 offen offset:3072 lds
    v_bfe_u32 v59, v255, 7, 1
    v_lshl_or_b32 v180, v59, 16, v180
    ds_read_b128 v[164:167], v51 offset:0
    ds_read_b128 v[168:171], v51 offset:16
    v_mfma_f32_32x32x16_bf16 v[96:111], a[168:171], a[72:75], v[96:111]
    s_waitcnt vmcnt(16) lgkmcnt(2)
    s_barrier
    ds_read_b128 a[192:195], v29 offset:0
    ds_read_b128 a[196:199], v30 offset:0
    s_add_u32 m0, s79, 20480
    s_add_u32 s83, s83, 114688
    buffer_load_dwordx4 v13, s[56:59], s83 offen offset:0 lds
    v_mfma_f32_32x32x16_bf16 v[96:111], a[172:175], a[76:79], v[96:111]
    ds_read_b128 a[200:203], v31 offset:0
    ds_read_b128 a[204:207], v32 offset:0
    ds_read_b128 v[172:175], v51 offset:128
    ds_read_b128 v[176:179], v51 offset:144
    s_mul_i32 s84, s77, 57344
    v_mfma_f32_32x32x16_bf16 v[96:111], a[176:179], a[80:83], v[96:111]
    ds_read_b128 a[208:211], v33 offset:0
    ds_read_b128 a[212:215], v34 offset:0
    buffer_load_dwordx4 v14, s[56:59], s83 offen offset:1024 lds
    s_lshl_b32 s80, s76, 11
    s_add_u32 s84, s84, s80
    v_mfma_f32_32x32x16_bf16 v[96:111], a[180:183], a[84:87], v[96:111]
    ds_read_b128 a[216:219], v35 offset:0
    ds_read_b128 a[220:223], v36 offset:0
    s_mov_b32 s81, s77
    s_bfe_u32 s81, s1, 0x30000
    s_lshl_b32 s80, s81, 13
    v_mfma_f32_32x32x16_bf16 v[96:111], a[184:187], a[88:91], v[96:111]
    buffer_load_dwordx4 v15, s[56:59], s83 offen offset:2048 lds
    s_add_u32 s3, s80, s84
    s_bfe_u32 s81, s1, 0x30003
    s_lshl_b32 s80, s81, 13
    s_add_u32 s38, s80, s84
    v_mfma_f32_32x32x16_bf16 v[96:111], a[188:191], a[92:95], v[96:111]
    s_bfe_u32 s81, s1, 0x30006
    s_lshl_b32 s80, s81, 13
    s_add_u32 s39, s80, s84
    s_bfe_u32 s81, s1, 0x30009
    s_lshl_b32 s80, s81, 13
    s_waitcnt lgkmcnt(0)
    v_mfma_f32_32x32x16_bf16 v[112:127], a[192:195], a[0:3], 0
    buffer_load_dwordx4 v16, s[56:59], s83 offen offset:3072 lds
    s_bfe_u32 s95, s0, 0x30000
    s_mul_i32 s95, s95, 57344
    s_add_u32 s95, s95, s88
    s_add_u32 s96, s80, s84
    v_mfma_f32_32x32x16_bf16 v[112:127], a[196:199], a[4:7], v[112:127]
    v_cvt_pk_bf16_f32 v144, v96, v97
    v_cvt_pk_bf16_f32 v145, v98, v99
    v_cvt_pk_bf16_f32 v146, v100, v101
    v_cvt_pk_bf16_f32 v147, v102, v103
    v_and_or_b32 v144, v144, v160, v161
    v_and_or_b32 v145, v145, v160, v162
    v_and_or_b32 v146, v146, v160, v163
    v_and_or_b32 v147, v147, v160, v180
    buffer_store_dwordx4 v[144:147], v41, s[68:71], s95 offen offset:0 sc1
    v_mfma_f32_32x32x16_bf16 v[112:127], a[200:203], a[8:11], v[112:127]
    s_waitcnt vmcnt(17)
    s_barrier
    ds_read_b64_tr_b16 a[224:225], v27 offset:4096
    ds_read_b64_tr_b16 a[226:227], v27 offset:4608
    ds_read_b64_tr_b16 a[228:229], v27 offset:5120
    s_add_u32 m0, s79, 0
    s_bfe_u32 s83, s0, 0x30009
    s_mul_i32 s83, s83, 57344
    s_add_u32 s83, s83, s87
    buffer_load_dwordx4 v2, s[60:63], s83 offen offset:0 lds
    v_cvt_pk_bf16_f32 v148, v104, v105
    v_cvt_pk_bf16_f32 v149, v106, v107
    v_cvt_pk_bf16_f32 v150, v108, v109
    v_cvt_pk_bf16_f32 v151, v110, v111
    v_and_or_b32 v148, v148, v160, v161
    v_and_or_b32 v149, v149, v160, v162
    v_and_or_b32 v150, v150, v160, v163
    v_and_or_b32 v151, v151, v160, v180
    buffer_store_dwordx4 v[148:151], v41, s[68:71], s95 offen offset:1024 sc1
    v_mfma_f32_32x32x16_bf16 v[112:127], a[204:207], a[12:15], v[112:127]
    ds_read_b64_tr_b16 a[230:231], v27 offset:5632
    ds_read_b64_tr_b16 a[232:233], v27 offset:28672
    ds_read_b64_tr_b16 a[234:235], v27 offset:29184
    s_bfe_u32 s81, s1, 0x3000c
    s_lshl_b32 s80, s81, 13
    v_mfma_f32_32x32x16_bf16 v[112:127], a[208:211], a[16:19], v[112:127]
    ds_read_b64_tr_b16 a[236:237], v27 offset:29696
    ds_read_b64_tr_b16 a[238:239], v27 offset:30208
    ds_read_b64_tr_b16 a[240:241], v28 offset:4096
    buffer_load_dwordx4 v3, s[60:63], s83 offen offset:1024 lds
    s_add_u32 s97, s80, s84
    v_mfma_f32_32x32x16_bf16 v[112:127], a[212:215], a[20:23], v[112:127]
    ds_read_b64_tr_b16 a[242:243], v28 offset:4608
    ds_read_b64_tr_b16 a[244:245], v28 offset:5120
    ds_read_b64_tr_b16 a[246:247], v28 offset:5632
    s_bfe_u32 s81, s1, 0x3000f
    s_lshl_b32 s80, s81, 13
    v_mfma_f32_32x32x16_bf16 v[112:127], a[216:219], a[24:27], v[112:127]
    ds_read_b64_tr_b16 a[248:249], v28 offset:28672
    ds_read_b64_tr_b16 a[250:251], v28 offset:29184
    ds_read_b64_tr_b16 a[252:253], v28 offset:29696
    buffer_load_dwordx4 v7, s[60:63], s83 offen offset:2048 lds
    s_add_u32 s22, s80, s84
    v_mfma_f32_32x32x16_bf16 v[112:127], a[220:223], a[28:31], v[112:127]
    ds_read_b64_tr_b16 a[254:255], v28 offset:30208
    s_waitcnt lgkmcnt(4)
    v_mfma_f32_32x32x16_bf16 v[112:127], a[224:227], a[32:35], v[112:127]
    buffer_load_dwordx4 v8, s[60:63], s83 offen offset:3072 lds
    v_mfma_f32_32x32x16_bf16 v[112:127], a[228:231], a[36:39], v[112:127]
    v_mfma_f32_32x32x16_bf16 v[112:127], a[232:235], a[40:43], v[112:127]
    s_waitcnt vmcnt(18) lgkmcnt(0)
    s_barrier
    ds_read_b64_tr_b16 a[96:97], v27 offset:8192
    ds_read_b64_tr_b16 a[98:99], v27 offset:8704
    ds_read_b64_tr_b16 a[100:101], v27 offset:9216
    s_add_u32 m0, s79, 4096
    s_bfe_u32 s83, s0, 0x30009
    s_lshl_b32 s83, s83, 7
    s_add_u32 s83, s83, s86
    buffer_load_dwordx4 v13, s[56:59], s83 offen offset:0 lds
    v_mfma_f32_32x32x16_bf16 v[112:127], a[236:239], a[44:47], v[112:127]
    ds_read_b64_tr_b16 a[102:103], v27 offset:9728
    ds_read_b64_tr_b16 a[104:105], v27 offset:32768
    ds_read_b64_tr_b16 a[106:107], v27 offset:33280
    v_mfma_f32_32x32x16_bf16 v[112:127], a[240:243], a[48:51], v[112:127]
    ds_read_b64_tr_b16 a[108:109], v27 offset:33792
    ds_read_b64_tr_b16 a[110:111], v27 offset:34304
    ds_read_b64_tr_b16 a[112:113], v28 offset:8192
    buffer_load_dwordx4 v14, s[56:59], s83 offen offset:1024 lds
    v_mfma_f32_32x32x16_bf16 v[112:127], a[244:247], a[52:55], v[112:127]
    ds_read_b64_tr_b16 a[114:115], v28 offset:8704
    ds_read_b64_tr_b16 a[116:117], v28 offset:9216
    ds_read_b64_tr_b16 a[118:119], v28 offset:9728
    v_mfma_f32_32x32x16_bf16 v[112:127], a[248:251], a[56:59], v[112:127]
    ds_read_b64_tr_b16 a[120:121], v28 offset:32768
    ds_read_b64_tr_b16 a[122:123], v28 offset:33280
    ds_read_b64_tr_b16 a[124:125], v28 offset:33792
    buffer_load_dwordx4 v15, s[56:59], s83 offen offset:2048 lds
    v_mfma_f32_32x32x16_bf16 v[112:127], a[252:255], a[60:63], v[112:127]
    ds_read_b64_tr_b16 a[126:127], v28 offset:34304
    s_waitcnt lgkmcnt(4)
    v_mfma_f32_32x32x16_bf16 v[112:127], a[96:99], a[64:67], v[112:127]
    buffer_load_dwordx4 v16, s[56:59], s83 offen offset:3072 lds
    v_mfma_f32_32x32x16_bf16 v[112:127], a[100:103], a[68:71], v[112:127]
    v_mfma_f32_32x32x16_bf16 v[112:127], a[104:107], a[72:75], v[112:127]
    s_waitcnt vmcnt(18) lgkmcnt(0)
    s_barrier
    ds_read_b128 a[128:131], v29 offset:12288
    ds_read_b128 a[132:135], v30 offset:12288
    s_add_u32 m0, s79, 8192
    s_add_u32 s83, s83, 114688
    buffer_load_dwordx4 v13, s[56:59], s83 offen offset:0 lds
    v_mfma_f32_32x32x16_bf16 v[112:127], a[108:111], a[76:79], v[112:127]
    ds_read_b128 a[136:139], v31 offset:12288
    ds_read_b128 a[140:143], v32 offset:12288
    v_mfma_f32_32x32x16_bf16 v[112:127], a[112:115], a[80:83], v[112:127]
    ds_read_b128 a[144:147], v33 offset:12288
    ds_read_b128 a[148:151], v34 offset:12288
    buffer_load_dwordx4 v14, s[56:59], s83 offen offset:1024 lds
    v_mfma_f32_32x32x16_bf16 v[112:127], a[116:119], a[84:87], v[112:127]
    ds_read_b128 a[152:155], v35 offset:12288
    ds_read_b128 a[156:159], v36 offset:12288
    v_mfma_f32_32x32x16_bf16 v[112:127], a[120:123], a[88:91], v[112:127]
    buffer_load_dwordx4 v15, s[56:59], s83 offen offset:2048 lds
    v_mfma_f32_32x32x16_bf16 v[112:127], a[124:127], a[92:95], v[112:127]
    s_waitcnt lgkmcnt(0)
    v_mfma_f32_32x32x16_bf16 v[96:111], a[128:131], a[0:3], 0
    buffer_load_dwordx4 v16, s[56:59], s83 offen offset:3072 lds
    s_bfe_u32 s95, s0, 0x30003
    s_mul_i32 s95, s95, 57344
    s_add_u32 s95, s95, s88
    v_mfma_f32_32x32x16_bf16 v[96:111], a[132:135], a[4:7], v[96:111]
    s_nop 4
    v_cvt_pk_bf16_f32 v152, v112, v113
    v_cvt_pk_bf16_f32 v153, v114, v115
    v_cvt_pk_bf16_f32 v154, v116, v117
    v_cvt_pk_bf16_f32 v155, v118, v119
    v_and_or_b32 v152, v152, v160, v161
    v_and_or_b32 v153, v153, v160, v162
    v_and_or_b32 v154, v154, v160, v163
    v_and_or_b32 v155, v155, v160, v180
    buffer_store_dwordx4 v[152:155], v41, s[68:71], s95 offen offset:0 sc1
    v_mfma_f32_32x32x16_bf16 v[96:111], a[136:139], a[8:11], v[96:111]
    s_waitcnt vmcnt(19)
    s_barrier
    ds_read_b64_tr_b16 a[160:161], v27 offset:16384
    ds_read_b64_tr_b16 a[162:163], v27 offset:16896
    ds_read_b64_tr_b16 a[164:165], v27 offset:17408
    s_add_u32 m0, s79, 12288
    s_bfe_u32 s83, s0, 0x3000c
    s_mul_i32 s83, s83, 57344
    s_add_u32 s83, s83, s87
    buffer_load_dwordx4 v2, s[60:63], s83 offen offset:0 lds
    v_cvt_pk_bf16_f32 v156, v120, v121
    v_cvt_pk_bf16_f32 v157, v122, v123
    v_cvt_pk_bf16_f32 v158, v124, v125
    v_cvt_pk_bf16_f32 v159, v126, v127
    v_and_or_b32 v156, v156, v160, v161
    v_and_or_b32 v157, v157, v160, v162
    v_and_or_b32 v158, v158, v160, v163
    v_and_or_b32 v159, v159, v160, v180
    buffer_store_dwordx4 v[156:159], v41, s[68:71], s95 offen offset:1024 sc1
    v_mfma_f32_32x32x16_bf16 v[96:111], a[140:143], a[12:15], v[96:111]
    ds_read_b64_tr_b16 a[166:167], v27 offset:17920
    ds_read_b64_tr_b16 a[168:169], v27 offset:40960
    ds_read_b64_tr_b16 a[170:171], v27 offset:41472
    v_mfma_f32_32x32x16_bf16 v[96:111], a[144:147], a[16:19], v[96:111]
    ds_read_b64_tr_b16 a[172:173], v27 offset:41984
    ds_read_b64_tr_b16 a[174:175], v27 offset:42496
    ds_read_b64_tr_b16 a[176:177], v28 offset:16384
    buffer_load_dwordx4 v3, s[60:63], s83 offen offset:1024 lds
    v_mfma_f32_32x32x16_bf16 v[96:111], a[148:151], a[20:23], v[96:111]
    ds_read_b64_tr_b16 a[178:179], v28 offset:16896
    ds_read_b64_tr_b16 a[180:181], v28 offset:17408
    ds_read_b64_tr_b16 a[182:183], v28 offset:17920
    v_mfma_f32_32x32x16_bf16 v[96:111], a[152:155], a[24:27], v[96:111]
    ds_read_b64_tr_b16 a[184:185], v28 offset:40960
    ds_read_b64_tr_b16 a[186:187], v28 offset:41472
    ds_read_b64_tr_b16 a[188:189], v28 offset:41984
    buffer_load_dwordx4 v7, s[60:63], s83 offen offset:2048 lds
    v_mfma_f32_32x32x16_bf16 v[96:111], a[156:159], a[28:31], v[96:111]
    ds_read_b64_tr_b16 a[190:191], v28 offset:42496
    s_waitcnt lgkmcnt(4)
    v_mfma_f32_32x32x16_bf16 v[96:111], a[160:163], a[32:35], v[96:111]
    buffer_load_dwordx4 v8, s[60:63], s83 offen offset:3072 lds
    v_mfma_f32_32x32x16_bf16 v[96:111], a[164:167], a[36:39], v[96:111]
    v_mfma_f32_32x32x16_bf16 v[96:111], a[168:171], a[40:43], v[96:111]
    s_waitcnt vmcnt(20) lgkmcnt(0)
    s_barrier
    ds_read_b64_tr_b16 a[192:193], v27 offset:20480
    ds_read_b64_tr_b16 a[194:195], v27 offset:20992
    ds_read_b64_tr_b16 a[196:197], v27 offset:21504
    s_add_u32 m0, s79, 16384
    s_bfe_u32 s83, s0, 0x3000c
    s_lshl_b32 s83, s83, 7
    s_add_u32 s83, s83, s86
    buffer_load_dwordx4 v13, s[56:59], s83 offen offset:0 lds
    v_mfma_f32_32x32x16_bf16 v[96:111], a[172:175], a[44:47], v[96:111]
    ds_read_b64_tr_b16 a[198:199], v27 offset:22016
    ds_read_b64_tr_b16 a[200:201], v27 offset:45056
    ds_read_b64_tr_b16 a[202:203], v27 offset:45568
    v_mfma_f32_32x32x16_bf16 v[96:111], a[176:179], a[48:51], v[96:111]
    ds_read_b64_tr_b16 a[204:205], v27 offset:46080
    ds_read_b64_tr_b16 a[206:207], v27 offset:46592
    ds_read_b64_tr_b16 a[208:209], v28 offset:20480
    buffer_load_dwordx4 v14, s[56:59], s83 offen offset:1024 lds
    v_mfma_f32_32x32x16_bf16 v[96:111], a[180:183], a[52:55], v[96:111]
    ds_read_b64_tr_b16 a[210:211], v28 offset:20992
    ds_read_b64_tr_b16 a[212:213], v28 offset:21504
    ds_read_b64_tr_b16 a[214:215], v28 offset:22016
    v_mfma_f32_32x32x16_bf16 v[96:111], a[184:187], a[56:59], v[96:111]
    ds_read_b64_tr_b16 a[216:217], v28 offset:45056
    ds_read_b64_tr_b16 a[218:219], v28 offset:45568
    ds_read_b64_tr_b16 a[220:221], v28 offset:46080
    buffer_load_dwordx4 v15, s[56:59], s83 offen offset:2048 lds
    v_mfma_f32_32x32x16_bf16 v[96:111], a[188:191], a[60:63], v[96:111]
    ds_read_b64_tr_b16 a[222:223], v28 offset:46592
    s_waitcnt lgkmcnt(4)
    v_mfma_f32_32x32x16_bf16 v[96:111], a[192:195], a[64:67], v[96:111]
    buffer_load_dwordx4 v16, s[56:59], s83 offen offset:3072 lds
    v_mfma_f32_32x32x16_bf16 v[96:111], a[196:199], a[68:71], v[96:111]
    v_mfma_f32_32x32x16_bf16 v[96:111], a[200:203], a[72:75], v[96:111]
    s_waitcnt vmcnt(18) lgkmcnt(0)
    s_barrier
    ds_read_b128 a[224:227], v29 offset:0
    ds_read_b128 a[228:231], v30 offset:0
    s_add_u32 m0, s79, 20480
    s_add_u32 s83, s83, 114688
    buffer_load_dwordx4 v13, s[56:59], s83 offen offset:0 lds
    v_mfma_f32_32x32x16_bf16 v[96:111], a[204:207], a[76:79], v[96:111]
    ds_read_b128 a[232:235], v31 offset:0
    ds_read_b128 a[236:239], v32 offset:0
    v_mfma_f32_32x32x16_bf16 v[96:111], a[208:211], a[80:83], v[96:111]
    ds_read_b128 a[240:243], v33 offset:0
    ds_read_b128 a[244:247], v34 offset:0
    buffer_load_dwordx4 v14, s[56:59], s83 offen offset:1024 lds
    v_mfma_f32_32x32x16_bf16 v[96:111], a[212:215], a[84:87], v[96:111]
    ds_read_b128 a[248:251], v35 offset:0
    ds_read_b128 a[252:255], v36 offset:0
    v_mfma_f32_32x32x16_bf16 v[96:111], a[216:219], a[88:91], v[96:111]
    buffer_load_dwordx4 v15, s[56:59], s83 offen offset:2048 lds
    v_mfma_f32_32x32x16_bf16 v[96:111], a[220:223], a[92:95], v[96:111]
    s_waitcnt lgkmcnt(0)
    v_mfma_f32_32x32x16_bf16 v[112:127], a[224:227], a[0:3], 0
    buffer_load_dwordx4 v16, s[56:59], s83 offen offset:3072 lds
    s_bfe_u32 s95, s0, 0x30006
    s_mul_i32 s95, s95, 57344
    s_add_u32 s95, s95, s88
    v_mfma_f32_32x32x16_bf16 v[112:127], a[228:231], a[4:7], v[112:127]
    s_nop 4
    v_cvt_pk_bf16_f32 v144, v96, v97
    v_cvt_pk_bf16_f32 v145, v98, v99
    v_cvt_pk_bf16_f32 v146, v100, v101
    v_cvt_pk_bf16_f32 v147, v102, v103
    v_and_or_b32 v144, v144, v160, v161
    v_and_or_b32 v145, v145, v160, v162
    v_and_or_b32 v146, v146, v160, v163
    v_and_or_b32 v147, v147, v160, v180
    buffer_store_dwordx4 v[144:147], v41, s[68:71], s95 offen offset:0 sc1
    v_mfma_f32_32x32x16_bf16 v[112:127], a[232:235], a[8:11], v[112:127]
    s_waitcnt vmcnt(19)
    s_barrier
    ds_read_b64_tr_b16 a[96:97], v27 offset:4096
    ds_read_b64_tr_b16 a[98:99], v27 offset:4608
    ds_read_b64_tr_b16 a[100:101], v27 offset:5120
    s_add_u32 m0, s79, 0
    s_bfe_u32 s83, s0, 0x3000f
    s_mul_i32 s83, s83, 57344
    s_add_u32 s83, s83, s87
    buffer_load_dwordx4 v2, s[60:63], s83 offen offset:0 lds
    v_cvt_pk_bf16_f32 v148, v104, v105
    v_cvt_pk_bf16_f32 v149, v106, v107
    v_cvt_pk_bf16_f32 v150, v108, v109
    v_cvt_pk_bf16_f32 v151, v110, v111
    v_and_or_b32 v148, v148, v160, v161
    v_and_or_b32 v149, v149, v160, v162
    v_and_or_b32 v150, v150, v160, v163
    v_and_or_b32 v151, v151, v160, v180
    buffer_store_dwordx4 v[148:151], v41, s[68:71], s95 offen offset:1024 sc1
    v_mfma_f32_32x32x16_bf16 v[112:127], a[236:239], a[12:15], v[112:127]
    ds_read_b64_tr_b16 a[102:103], v27 offset:5632
    ds_read_b64_tr_b16 a[104:105], v27 offset:28672
    ds_read_b64_tr_b16 a[106:107], v27 offset:29184
    v_mfma_f32_32x32x16_bf16 v[112:127], a[240:243], a[16:19], v[112:127]
    ds_read_b64_tr_b16 a[108:109], v27 offset:29696
    ds_read_b64_tr_b16 a[110:111], v27 offset:30208
    ds_read_b64_tr_b16 a[112:113], v28 offset:4096
    buffer_load_dwordx4 v3, s[60:63], s83 offen offset:1024 lds
    v_mfma_f32_32x32x16_bf16 v[112:127], a[244:247], a[20:23], v[112:127]
    ds_read_b64_tr_b16 a[114:115], v28 offset:4608
    ds_read_b64_tr_b16 a[116:117], v28 offset:5120
    ds_read_b64_tr_b16 a[118:119], v28 offset:5632
    v_mfma_f32_32x32x16_bf16 v[112:127], a[248:251], a[24:27], v[112:127]
    ds_read_b64_tr_b16 a[120:121], v28 offset:28672
    ds_read_b64_tr_b16 a[122:123], v28 offset:29184
    ds_read_b64_tr_b16 a[124:125], v28 offset:29696
    buffer_load_dwordx4 v7, s[60:63], s83 offen offset:2048 lds
    v_mfma_f32_32x32x16_bf16 v[112:127], a[252:255], a[28:31], v[112:127]
    ds_read_b64_tr_b16 a[126:127], v28 offset:30208
    s_waitcnt lgkmcnt(4)
    v_mfma_f32_32x32x16_bf16 v[112:127], a[96:99], a[32:35], v[112:127]
    buffer_load_dwordx4 v8, s[60:63], s83 offen offset:3072 lds
    v_mfma_f32_32x32x16_bf16 v[112:127], a[100:103], a[36:39], v[112:127]
    v_mfma_f32_32x32x16_bf16 v[112:127], a[104:107], a[40:43], v[112:127]
    s_waitcnt vmcnt(20) lgkmcnt(0)
    s_barrier
    ds_read_b64_tr_b16 a[128:129], v27 offset:8192
    ds_read_b64_tr_b16 a[130:131], v27 offset:8704
    ds_read_b64_tr_b16 a[132:133], v27 offset:9216
    s_add_u32 m0, s79, 4096
    s_bfe_u32 s83, s0, 0x3000f
    s_lshl_b32 s83, s83, 7
    s_add_u32 s83, s83, s86
    buffer_load_dwordx4 v13, s[56:59], s83 offen offset:0 lds
    v_mfma_f32_32x32x16_bf16 v[112:127], a[108:111], a[44:47], v[112:127]
    ds_read_b64_tr_b16 a[134:135], v27 offset:9728
    ds_read_b64_tr_b16 a[136:137], v27 offset:32768
    ds_read_b64_tr_b16 a[138:139], v27 offset:33280
    v_mfma_f32_32x32x16_bf16 v[112:127], a[112:115], a[48:51], v[112:127]
    ds_read_b64_tr_b16 a[140:141], v27 offset:33792
    ds_read_b64_tr_b16 a[142:143], v27 offset:34304
    ds_read_b64_tr_b16 a[144:145], v28 offset:8192
    buffer_load_dwordx4 v14, s[56:59], s83 offen offset:1024 lds
    v_mfma_f32_32x32x16_bf16 v[112:127], a[116:119], a[52:55], v[112:127]
    ds_read_b64_tr_b16 a[146:147], v28 offset:8704
    ds_read_b64_tr_b16 a[148:149], v28 offset:9216
    ds_read_b64_tr_b16 a[150:151], v28 offset:9728
    v_mfma_f32_32x32x16_bf16 v[112:127], a[120:123], a[56:59], v[112:127]
    ds_read_b64_tr_b16 a[152:153], v28 offset:32768
    ds_read_b64_tr_b16 a[154:155], v28 offset:33280
    ds_read_b64_tr_b16 a[156:157], v28 offset:33792
    buffer_load_dwordx4 v15, s[56:59], s83 offen offset:2048 lds
    v_mfma_f32_32x32x16_bf16 v[112:127], a[124:127], a[60:63], v[112:127]
    ds_read_b64_tr_b16 a[158:159], v28 offset:34304
    s_waitcnt lgkmcnt(4)
    v_mfma_f32_32x32x16_bf16 v[112:127], a[128:131], a[64:67], v[112:127]
    buffer_load_dwordx4 v16, s[56:59], s83 offen offset:3072 lds
    v_mfma_f32_32x32x16_bf16 v[112:127], a[132:135], a[68:71], v[112:127]
    v_mfma_f32_32x32x16_bf16 v[112:127], a[136:139], a[72:75], v[112:127]
    s_waitcnt vmcnt(18) lgkmcnt(0)
    s_barrier
    ds_read_b128 a[160:163], v29 offset:12288
    ds_read_b128 a[164:167], v30 offset:12288
    s_add_u32 m0, s79, 8192
    s_add_u32 s83, s83, 114688
    buffer_load_dwordx4 v13, s[56:59], s83 offen offset:0 lds
    v_mfma_f32_32x32x16_bf16 v[112:127], a[140:143], a[76:79], v[112:127]
    ds_read_b128 a[168:171], v31 offset:12288
    ds_read_b128 a[172:175], v32 offset:12288
    v_mfma_f32_32x32x16_bf16 v[112:127], a[144:147], a[80:83], v[112:127]
    ds_read_b128 a[176:179], v33 offset:12288
    ds_read_b128 a[180:183], v34 offset:12288
    buffer_load_dwordx4 v14, s[56:59], s83 offen offset:1024 lds
    v_mfma_f32_32x32x16_bf16 v[112:127], a[148:151], a[84:87], v[112:127]
    ds_read_b128 a[184:187], v35 offset:12288
    ds_read_b128 a[188:191], v36 offset:12288
    v_mfma_f32_32x32x16_bf16 v[112:127], a[152:155], a[88:91], v[112:127]
    buffer_load_dwordx4 v15, s[56:59], s83 offen offset:2048 lds
    v_mfma_f32_32x32x16_bf16 v[112:127], a[156:159], a[92:95], v[112:127]
    s_waitcnt lgkmcnt(0)
    v_mfma_f32_32x32x16_bf16 v[96:111], a[160:163], a[0:3], 0
    buffer_load_dwordx4 v16, s[56:59], s83 offen offset:3072 lds
    s_bfe_u32 s95, s0, 0x30009
    s_mul_i32 s95, s95, 57344
    s_add_u32 s95, s95, s88
    v_mfma_f32_32x32x16_bf16 v[96:111], a[164:167], a[4:7], v[96:111]
    s_nop 4
    v_cvt_pk_bf16_f32 v152, v112, v113
    v_cvt_pk_bf16_f32 v153, v114, v115
    v_cvt_pk_bf16_f32 v154, v116, v117
    v_cvt_pk_bf16_f32 v155, v118, v119
    v_and_or_b32 v152, v152, v160, v161
    v_and_or_b32 v153, v153, v160, v162
    v_and_or_b32 v154, v154, v160, v163
    v_and_or_b32 v155, v155, v160, v180
    buffer_store_dwordx4 v[152:155], v41, s[68:71], s95 offen offset:0 sc1
    v_mfma_f32_32x32x16_bf16 v[96:111], a[168:171], a[8:11], v[96:111]
    s_waitcnt vmcnt(19)
    s_barrier
    ds_read_b64_tr_b16 a[192:193], v27 offset:16384
    ds_read_b64_tr_b16 a[194:195], v27 offset:16896
    ds_read_b64_tr_b16 a[196:197], v27 offset:17408
    s_add_u32 m0, s79, 12288
    s_mov_b32 s83, s77
    s_mul_i32 s83, s83, 57344
    s_add_u32 s83, s83, s87
    buffer_load_dwordx4 v2, s[60:63], s83 offen offset:0 lds
    v_cvt_pk_bf16_f32 v156, v120, v121
    v_cvt_pk_bf16_f32 v157, v122, v123
    v_cvt_pk_bf16_f32 v158, v124, v125
    v_cvt_pk_bf16_f32 v159, v126, v127
    v_and_or_b32 v156, v156, v160, v161
    v_and_or_b32 v157, v157, v160, v162
    v_and_or_b32 v158, v158, v160, v163
    v_and_or_b32 v159, v159, v160, v180
    buffer_store_dwordx4 v[156:159], v41, s[68:71], s95 offen offset:1024 sc1
    v_mfma_f32_32x32x16_bf16 v[96:111], a[172:175], a[12:15], v[96:111]
    ds_read_b64_tr_b16 a[198:199], v27 offset:17920
    ds_read_b64_tr_b16 a[200:201], v27 offset:40960
    ds_read_b64_tr_b16 a[202:203], v27 offset:41472
    v_mfma_f32_32x32x16_bf16 v[96:111], a[176:179], a[16:19], v[96:111]
    ds_read_b64_tr_b16 a[204:205], v27 offset:41984
    ds_read_b64_tr_b16 a[206:207], v27 offset:42496
    ds_read_b64_tr_b16 a[208:209], v28 offset:16384
    buffer_load_dwordx4 v3, s[60:63], s83 offen offset:1024 lds
    v_lshlrev_b32 v59, 16, v184
    v_mfma_f32_32x32x16_bf16 v[96:111], a[180:183], a[20:23], v[96:111]
    ds_read_b64_tr_b16 a[210:211], v28 offset:16896
    ds_read_b64_tr_b16 a[212:213], v28 offset:17408
    ds_read_b64_tr_b16 a[214:215], v28 offset:17920
    v_and_b32 v60, 0xffff0000, v184
    v_lshlrev_b32 v61, 16, v164
    v_mfma_f32_32x32x16_bf16 v[96:111], a[184:187], a[24:27], v[96:111]
    ds_read_b64_tr_b16 a[216:217], v28 offset:40960
    ds_read_b64_tr_b16 a[218:219], v28 offset:41472
    ds_read_b64_tr_b16 a[220:221], v28 offset:41984
    buffer_load_dwordx4 v7, s[60:63], s83 offen offset:2048 lds
    v_and_b32 v62, 0xffff0000, v164
    v_mfma_f32_32x32x16_bf16 v[96:111], a[188:191], a[28:31], v[96:111]
    ds_read_b64_tr_b16 a[222:223], v28 offset:42496
    v_mul_f32 v59, v59, v61
    v_mul_f32 v60, v60, v62
    v_lshlrev_b32 v192, 16, v172
    v_cvt_pk_bf16_f32 v59, v59, v60
    s_waitcnt lgkmcnt(4)
    v_mfma_f32_32x32x16_bf16 v[96:111], a[192:195], a[32:35], v[96:111]
    buffer_load_dwordx4 v8, s[60:63], s83 offen offset:3072 lds
    v_and_b32 v193, 0xffff0000, v172
    v_mul_f32 v192, v57, v192
    v_and_b32 v60, 0xffff0000, v59
    v_lshlrev_b32 v59, 16, v59
    v_mfma_f32_32x32x16_bf16 v[96:111], a[196:199], a[36:39], v[96:111]
    v_mul_f32 v193, v57, v193
    v_fmac_f32 v192, v56, v59
    v_fmac_f32 v193, v56, v60
    v_lshlrev_b32 v59, 16, v185
    v_and_b32 v60, 0xffff0000, v185
    v_mfma_f32_32x32x16_bf16 v[96:111], a[200:203], a[40:43], v[96:111]
    s_waitcnt vmcnt(20) lgkmcnt(0)
    s_barrier
    ds_read_b64_tr_b16 a[224:225], v27 offset:20480
    ds_read_b64_tr_b16 a[226:227], v27 offset:20992
    ds_read_b64_tr_b16 a[228:229], v27 offset:21504
    s_add_u32 m0, s79, 16384
    s_mov_b32 s83, s77
    s_lshl_b32 s83, s83, 7
    s_add_u32 s83, s83, s86
    buffer_load_dwordx4 v13, s[56:59], s83 offen offset:0 lds
    v_mfma_f32_32x32x16_bf16 v[96:111], a[204:207], a[44:47], v[96:111]
    ds_read_b64_tr_b16 a[230:231], v27 offset:22016
    ds_read_b64_tr_b16 a[232:233], v27 offset:45056
    ds_read_b64_tr_b16 a[234:235], v27 offset:45568
    v_lshlrev_b32 v61, 16, v165
    v_and_b32 v62, 0xffff0000, v165
    v_mfma_f32_32x32x16_bf16 v[96:111], a[208:211], a[48:51], v[96:111]
    ds_read_b64_tr_b16 a[236:237], v27 offset:46080
    ds_read_b64_tr_b16 a[238:239], v27 offset:46592
    ds_read_b64_tr_b16 a[240:241], v28 offset:20480
    buffer_load_dwordx4 v14, s[56:59], s83 offen offset:1024 lds
    v_mul_f32 v59, v59, v61
    v_mfma_f32_32x32x16_bf16 v[96:111], a[212:215], a[52:55], v[96:111]
    ds_read_b64_tr_b16 a[242:243], v28 offset:20992
    ds_read_b64_tr_b16 a[244:245], v28 offset:21504
    ds_read_b64_tr_b16 a[246:247], v28 offset:22016
    v_mul_f32 v60, v60, v62
    v_lshlrev_b32 v194, 16, v173
    v_mfma_f32_32x32x16_bf16 v[96:111], a[216:219], a[56:59], v[96:111]
    ds_read_b64_tr_b16 a[248:249], v28 offset:45056
    ds_read_b64_tr_b16 a[250:251], v28 offset:45568
    ds_read_b64_tr_b16 a[252:253], v28 offset:46080
    buffer_load_dwordx4 v15, s[56:59], s83 offen offset:2048 lds
    v_cvt_pk_bf16_f32 v59, v59, v60
    v_mfma_f32_32x32x16_bf16 v[96:111], a[220:223], a[60:63], v[96:111]
    ds_read_b64_tr_b16 a[254:255], v28 offset:46592
    v_and_b32 v195, 0xffff0000, v173
    v_mul_f32 v194, v57, v194
    v_and_b32 v60, 0xffff0000, v59
    v_lshlrev_b32 v59, 16, v59
    s_waitcnt lgkmcnt(4)
    v_mfma_f32_32x32x16_bf16 v[96:111], a[224:227], a[64:67], v[96:111]
    buffer_load_dwordx4 v16, s[56:59], s83 offen offset:3072 lds
    v_mul_f32 v195, v57, v195
    v_fmac_f32 v194, v56, v59
    v_fmac_f32 v195, v56, v60
    v_mfma_f32_32x32x16_bf16 v[96:111], a[228:231], a[68:71], v[96:111]
    v_mfma_f32_32x32x16_bf16 v[96:111], a[232:235], a[72:75], v[96:111]
    s_waitcnt vmcnt(18) lgkmcnt(0)
    s_barrier
    ds_read_b128 a[96:99], v29 offset:0
    ds_read_b128 a[100:103], v30 offset:0
    s_add_u32 m0, s79, 20480
    s_add_u32 s83, s83, 114688
    buffer_load_dwordx4 v13, s[56:59], s83 offen offset:0 lds
    v_mfma_f32_32x32x16_bf16 v[96:111], a[236:239], a[76:79], v[96:111]
    ds_read_b128 a[104:107], v31 offset:0
    ds_read_b128 a[108:111], v32 offset:0
    v_lshlrev_b32 v59, 16, v186
    v_and_b32 v60, 0xffff0000, v186
    v_lshlrev_b32 v61, 16, v166
    v_mfma_f32_32x32x16_bf16 v[96:111], a[240:243], a[80:83], v[96:111]
    ds_read_b128 a[112:115], v33 offset:0
    ds_read_b128 a[116:119], v34 offset:0
    buffer_load_dwordx4 v14, s[56:59], s83 offen offset:1024 lds
    v_and_b32 v62, 0xffff0000, v166
    v_mul_f32 v59, v59, v61
    v_mfma_f32_32x32x16_bf16 v[96:111], a[244:247], a[84:87], v[96:111]
    ds_read_b128 a[120:123], v35 offset:0
    ds_read_b128 a[124:127], v36 offset:0
    v_mul_f32 v60, v60, v62
    v_lshlrev_b32 v196, 16, v174
    v_cvt_pk_bf16_f32 v59, v59, v60
    v_mfma_f32_32x32x16_bf16 v[96:111], a[248:251], a[88:91], v[96:111]
    buffer_load_dwordx4 v15, s[56:59], s83 offen offset:2048 lds
    v_and_b32 v197, 0xffff0000, v174
    v_mul_f32 v196, v57, v196
    v_and_b32 v60, 0xffff0000, v59
    v_lshlrev_b32 v59, 16, v59
    v_mfma_f32_32x32x16_bf16 v[96:111], a[252:255], a[92:95], v[96:111]
    v_mul_f32 v197, v57, v197
    v_fmac_f32 v196, v56, v59
    v_fmac_f32 v197, v56, v60
    v_lshlrev_b32 v59, 16, v187
    v_and_b32 v60, 0xffff0000, v187
    s_waitcnt lgkmcnt(0)
    v_mfma_f32_32x32x16_bf16 v[112:127], a[96:99], a[0:3], 0
    buffer_load_dwordx4 v16, s[56:59], s83 offen offset:3072 lds
    s_bfe_u32 s95, s0, 0x3000c
    s_mul_i32 s95, s95, 57344
    s_add_u32 s95, s95, s88
    v_lshlrev_b32 v61, 16, v167
    v_mfma_f32_32x32x16_bf16 v[112:127], a[100:103], a[4:7], v[112:127]
    v_cvt_pk_bf16_f32 v144, v96, v97
    v_cvt_pk_bf16_f32 v145, v98, v99
    v_cvt_pk_bf16_f32 v146, v100, v101
    v_cvt_pk_bf16_f32 v147, v102, v103
    v_and_or_b32 v144, v144, v160, v161
    v_and_or_b32 v145, v145, v160, v162
    v_and_or_b32 v146, v146, v160, v163
    v_and_or_b32 v147, v147, v160, v180
    buffer_store_dwordx4 v[144:147], v41, s[68:71], s95 offen offset:0 sc1
    v_mfma_f32_32x32x16_bf16 v[112:127], a[104:107], a[8:11], v[112:127]
    s_waitcnt vmcnt(19)
    s_barrier
    ds_read_b64_tr_b16 a[128:129], v27 offset:4096
    ds_read_b64_tr_b16 a[130:131], v27 offset:4608
    ds_read_b64_tr_b16 a[132:133], v27 offset:5120
    v_cvt_pk_bf16_f32 v148, v104, v105
    v_cvt_pk_bf16_f32 v149, v106, v107
    v_cvt_pk_bf16_f32 v150, v108, v109
    v_cvt_pk_bf16_f32 v151, v110, v111
    v_and_or_b32 v148, v148, v160, v161
    v_and_or_b32 v149, v149, v160, v162
    v_and_or_b32 v150, v150, v160, v163
    v_and_or_b32 v151, v151, v160, v180
    buffer_store_dwordx4 v[148:151], v41, s[68:71], s95 offen offset:1024 sc1
    v_mfma_f32_32x32x16_bf16 v[112:127], a[108:111], a[12:15], v[112:127]
    ds_read_b64_tr_b16 a[134:135], v27 offset:5632
    ds_read_b64_tr_b16 a[136:137], v27 offset:28672
    ds_read_b64_tr_b16 a[138:139], v27 offset:29184
    v_and_b32 v62, 0xffff0000, v167
    v_mul_f32 v59, v59, v61
    v_mfma_f32_32x32x16_bf16 v[112:127], a[112:115], a[16:19], v[112:127]
    ds_read_b64_tr_b16 a[140:141], v27 offset:29696
    ds_read_b64_tr_b16 a[142:143], v27 offset:30208
    ds_read_b64_tr_b16 a[144:145], v28 offset:4096
    v_mul_f32 v60, v60, v62
    v_lshlrev_b32 v198, 16, v175
    v_mfma_f32_32x32x16_bf16 v[112:127], a[116:119], a[20:23], v[112:127]
    ds_read_b64_tr_b16 a[146:147], v28 offset:4608
    ds_read_b64_tr_b16 a[148:149], v28 offset:5120
    ds_read_b64_tr_b16 a[150:151], v28 offset:5632
    v_cvt_pk_bf16_f32 v59, v59, v60
    v_and_b32 v199, 0xffff0000, v175
    v_mfma_f32_32x32x16_bf16 v[112:127], a[120:123], a[24:27], v[112:127]
    ds_read_b64_tr_b16 a[152:153], v28 offset:28672
    ds_read_b64_tr_b16 a[154:155], v28 offset:29184
    ds_read_b64_tr_b16 a[156:157], v28 offset:29696
    v_mul_f32 v198, v57, v198
    v_and_b32 v60, 0xffff0000, v59
    v_mfma_f32_32x32x16_bf16 v[112:127], a[124:127], a[28:31], v[112:127]
    ds_read_b64_tr_b16 a[158:159], v28 offset:30208
    v_lshlrev_b32 v59, 16, v59
    v_mul_f32 v199, v57, v199
    v_fmac_f32 v198, v56, v59
    v_fmac_f32 v199, v56, v60
    s_waitcnt lgkmcnt(4)
    v_mfma_f32_32x32x16_bf16 v[112:127], a[128:131], a[32:35], v[112:127]
    v_lshlrev_b32 v59, 16, v188
    v_and_b32 v60, 0xffff0000, v188
    v_lshlrev_b32 v61, 16, v168
    v_and_b32 v62, 0xffff0000, v168
    v_mul_f32 v59, v59, v61
    v_mfma_f32_32x32x16_bf16 v[112:127], a[132:135], a[36:39], v[112:127]
    v_mul_f32 v60, v60, v62
    v_lshlrev_b32 v200, 16, v176
    v_cvt_pk_bf16_f32 v59, v59, v60
    v_and_b32 v201, 0xffff0000, v176
    v_mul_f32 v200, v57, v200
    v_mfma_f32_32x32x16_bf16 v[112:127], a[136:139], a[40:43], v[112:127]
    s_waitcnt vmcnt(16) lgkmcnt(0)
    s_barrier
    ds_read_b64_tr_b16 a[160:161], v27 offset:8192
    ds_read_b64_tr_b16 a[162:163], v27 offset:8704
    ds_read_b64_tr_b16 a[164:165], v27 offset:9216
    v_and_b32 v60, 0xffff0000, v59
    v_mfma_f32_32x32x16_bf16 v[112:127], a[140:143], a[44:47], v[112:127]
    ds_read_b64_tr_b16 a[166:167], v27 offset:9728
    ds_read_b64_tr_b16 a[168:169], v27 offset:32768
    ds_read_b64_tr_b16 a[170:171], v27 offset:33280
    v_lshlrev_b32 v59, 16, v59
    v_mul_f32 v201, v57, v201
    v_mfma_f32_32x32x16_bf16 v[112:127], a[144:147], a[48:51], v[112:127]
    ds_read_b64_tr_b16 a[172:173], v27 offset:33792
    ds_read_b64_tr_b16 a[174:175], v27 offset:34304
    ds_read_b64_tr_b16 a[176:177], v28 offset:8192
    v_fmac_f32 v200, v56, v59
    v_fmac_f32 v201, v56, v60
    v_mfma_f32_32x32x16_bf16 v[112:127], a[148:151], a[52:55], v[112:127]
    ds_read_b64_tr_b16 a[178:179], v28 offset:8704
    ds_read_b64_tr_b16 a[180:181], v28 offset:9216
    ds_read_b64_tr_b16 a[182:183], v28 offset:9728
    v_lshlrev_b32 v59, 16, v189
    v_and_b32 v60, 0xffff0000, v189
    v_mfma_f32_32x32x16_bf16 v[112:127], a[152:155], a[56:59], v[112:127]
    ds_read_b64_tr_b16 a[184:185], v28 offset:32768
    ds_read_b64_tr_b16 a[186:187], v28 offset:33280
    ds_read_b64_tr_b16 a[188:189], v28 offset:33792
    v_lshlrev_b32 v61, 16, v169
    v_and_b32 v62, 0xffff0000, v169
    v_mfma_f32_32x32x16_bf16 v[112:127], a[156:159], a[60:63], v[112:127]
    ds_read_b64_tr_b16 a[190:191], v28 offset:34304
    v_mul_f32 v59, v59, v61
    v_mul_f32 v60, v60, v62
    v_lshlrev_b32 v202, 16, v177
    v_cvt_pk_bf16_f32 v59, v59, v60
    s_waitcnt lgkmcnt(4)
    v_mfma_f32_32x32x16_bf16 v[112:127], a[160:163], a[64:67], v[112:127]
    v_and_b32 v203, 0xffff0000, v177
    v_mul_f32 v202, v57, v202
    v_and_b32 v60, 0xffff0000, v59
    v_lshlrev_b32 v59, 16, v59
    v_mul_f32 v203, v57, v203
    v_mfma_f32_32x32x16_bf16 v[112:127], a[164:167], a[68:71], v[112:127]
    v_fmac_f32 v202, v56, v59
    v_fmac_f32 v203, v56, v60
    buffer_load_dwordx4 v[64:67], v41, s[68:71], s3 offen offset:0 sc1
    buffer_load_dwordx4 v[68:71], v41, s[68:71], s3 offen offset:1024 sc1
    buffer_load_dwordx4 v[72:75], v41, s[68:71], s38 offen offset:0 sc1
    v_mfma_f32_32x32x16_bf16 v[112:127], a[168:171], a[72:75], v[112:127]
    s_waitcnt vmcnt(13) lgkmcnt(0)
    s_barrier
    ds_read_b128 a[192:195], v29 offset:12288
    ds_read_b128 a[196:199], v30 offset:12288
    buffer_load_dwordx4 v[76:79], v41, s[68:71], s38 offen offset:1024 sc1
    v_mfma_f32_32x32x16_bf16 v[112:127], a[172:175], a[76:79], v[112:127]
    ds_read_b128 a[200:203], v31 offset:12288
    ds_read_b128 a[204:207], v32 offset:12288
    v_mfma_f32_32x32x16_bf16 v[112:127], a[176:179], a[80:83], v[112:127]
    ds_read_b128 a[208:211], v33 offset:12288
    ds_read_b128 a[212:215], v34 offset:12288
    v_mfma_f32_32x32x16_bf16 v[112:127], a[180:183], a[84:87], v[112:127]
    ds_read_b128 a[216:219], v35 offset:12288
    ds_read_b128 a[220:223], v36 offset:12288
    v_mfma_f32_32x32x16_bf16 v[112:127], a[184:187], a[88:91], v[112:127]
    v_lshlrev_b32 v59, 16, v190
    v_and_b32 v60, 0xffff0000, v190
    v_lshlrev_b32 v61, 16, v170
    v_and_b32 v62, 0xffff0000, v170
    v_mul_f32 v59, v59, v61
    v_mfma_f32_32x32x16_bf16 v[112:127], a[188:191], a[92:95], v[112:127]
    v_mul_f32 v60, v60, v62
    v_lshlrev_b32 v204, 16, v178
    v_cvt_pk_bf16_f32 v59, v59, v60
    v_and_b32 v205, 0xffff0000, v178
    v_mul_f32 v204, v57, v204
    s_waitcnt lgkmcnt(0)
    v_mfma_f32_32x32x16_bf16 v[96:111], a[192:195], a[0:3], 0
    s_bfe_u32 s95, s0, 0x3000f
    s_mul_i32 s95, s95, 57344
    s_add_u32 s95, s95, s88
    v_and_b32 v60, 0xffff0000, v59
    v_lshlrev_b32 v59, 16, v59
    v_mfma_f32_32x32x16_bf16 v[96:111], a[196:199], a[4:7], v[96:111]
    v_cvt_pk_bf16_f32 v152, v112, v113
    v_cvt_pk_bf16_f32 v153, v114, v115
    v_cvt_pk_bf16_f32 v154, v116, v117
    v_cvt_pk_bf16_f32 v155, v118, v119
    v_and_or_b32 v152, v152, v160, v161
    v_and_or_b32 v153, v153, v160, v162
    v_and_or_b32 v154, v154, v160, v163
    v_and_or_b32 v155, v155, v160, v180
    buffer_store_dwordx4 v[152:155], v41, s[68:71], s95 offen offset:0 sc1
    v_mfma_f32_32x32x16_bf16 v[96:111], a[200:203], a[8:11], v[96:111]
    s_waitcnt vmcnt(11)
    s_barrier
    ds_read_b64_tr_b16 a[224:225], v27 offset:16384
    ds_read_b64_tr_b16 a[226:227], v27 offset:16896
    ds_read_b64_tr_b16 a[228:229], v27 offset:17408
    v_cvt_pk_bf16_f32 v156, v120, v121
    v_cvt_pk_bf16_f32 v157, v122, v123
    v_cvt_pk_bf16_f32 v158, v124, v125
    v_cvt_pk_bf16_f32 v159, v126, v127
    v_and_or_b32 v156, v156, v160, v161
    v_and_or_b32 v157, v157, v160, v162
    v_and_or_b32 v158, v158, v160, v163
    v_and_or_b32 v159, v159, v160, v180
    buffer_store_dwordx4 v[156:159], v41, s[68:71], s95 offen offset:1024 sc1
    v_mfma_f32_32x32x16_bf16 v[96:111], a[204:207], a[12:15], v[96:111]
    ds_read_b64_tr_b16 a[230:231], v27 offset:17920
    ds_read_b64_tr_b16 a[232:233], v27 offset:40960
    ds_read_b64_tr_b16 a[234:235], v27 offset:41472
    v_mul_f32 v205, v57, v205
    v_fmac_f32 v204, v56, v59
    v_mfma_f32_32x32x16_bf16 v[96:111], a[208:211], a[16:19], v[96:111]
    ds_read_b64_tr_b16 a[236:237], v27 offset:41984
    ds_read_b64_tr_b16 a[238:239], v27 offset:42496
    ds_read_b64_tr_b16 a[240:241], v28 offset:16384
    v_fmac_f32 v205, v56, v60
    v_lshlrev_b32 v59, 16, v191
    v_mfma_f32_32x32x16_bf16 v[96:111], a[212:215], a[20:23], v[96:111]
    ds_read_b64_tr_b16 a[242:243], v28 offset:16896
    ds_read_b64_tr_b16 a[244:245], v28 offset:17408
    ds_read_b64_tr_b16 a[246:247], v28 offset:17920
    v_and_b32 v60, 0xffff0000, v191
    v_lshlrev_b32 v61, 16, v171
    v_mfma_f32_32x32x16_bf16 v[96:111], a[216:219], a[24:27], v[96:111]
    ds_read_b64_tr_b16 a[248:249], v28 offset:40960
    ds_read_b64_tr_b16 a[250:251], v28 offset:41472
    ds_read_b64_tr_b16 a[252:253], v28 offset:41984
    v_and_b32 v62, 0xffff0000, v171
    v_mul_f32 v59, v59, v61
    v_mfma_f32_32x32x16_bf16 v[96:111], a[220:223], a[28:31], v[96:111]
    ds_read_b64_tr_b16 a[254:255], v28 offset:42496
    v_mul_f32 v60, v60, v62
    v_lshlrev_b32 v206, 16, v179
    v_cvt_pk_bf16_f32 v59, v59, v60
    v_and_b32 v207, 0xffff0000, v179
    s_waitcnt lgkmcnt(4)
    v_mfma_f32_32x32x16_bf16 v[96:111], a[224:227], a[32:35], v[96:111]
    v_mul_f32 v206, v57, v206
    v_and_b32 v60, 0xffff0000, v59
    v_lshlrev_b32 v59, 16, v59
    v_mul_f32 v207, v57, v207
    v_fmac_f32 v206, v56, v59
    v_mfma_f32_32x32x16_bf16 v[96:111], a[228:231], a[36:39], v[96:111]
    v_fmac_f32 v207, v56, v60
    buffer_load_dwordx4 v[80:83], v41, s[68:71], s39 offen offset:0 sc1
    buffer_load_dwordx4 v[84:87], v41, s[68:71], s39 offen offset:1024 sc1
    v_mfma_f32_32x32x16_bf16 v[96:111], a[232:235], a[40:43], v[96:111]
    s_waitcnt vmcnt(10) lgkmcnt(0)
    s_barrier
    ds_read_b64_tr_b16 a[96:97], v27 offset:20480
    ds_read_b64_tr_b16 a[98:99], v27 offset:20992
    ds_read_b64_tr_b16 a[100:101], v27 offset:21504
    v_mfma_f32_32x32x16_bf16 v[96:111], a[236:239], a[44:47], v[96:111]
    ds_read_b64_tr_b16 a[102:103], v27 offset:22016
    ds_read_b64_tr_b16 a[104:105], v27 offset:45056
    ds_read_b64_tr_b16 a[106:107], v27 offset:45568
    v_mfma_f32_32x32x16_bf16 v[96:111], a[240:243], a[48:51], v[96:111]
    ds_read_b64_tr_b16 a[108:109], v27 offset:46080
    ds_read_b64_tr_b16 a[110:111], v27 offset:46592
    ds_read_b64_tr_b16 a[112:113], v28 offset:20480
    v_mfma_f32_32x32x16_bf16 v[96:111], a[244:247], a[52:55], v[96:111]
    ds_read_b64_tr_b16 a[114:115], v28 offset:20992
    ds_read_b64_tr_b16 a[116:117], v28 offset:21504
    ds_read_b64_tr_b16 a[118:119], v28 offset:22016
    v_mfma_f32_32x32x16_bf16 v[96:111], a[248:251], a[56:59], v[96:111]
    ds_read_b64_tr_b16 a[120:121], v28 offset:45056
    ds_read_b64_tr_b16 a[122:123], v28 offset:45568
    ds_read_b64_tr_b16 a[124:125], v28 offset:46080
    v_mfma_f32_32x32x16_bf16 v[96:111], a[252:255], a[60:63], v[96:111]
    ds_read_b64_tr_b16 a[126:127], v28 offset:46592
    s_waitcnt lgkmcnt(4)
    v_mfma_f32_32x32x16_bf16 v[96:111], a[96:99], a[64:67], v[96:111]
    v_mfma_f32_32x32x16_bf16 v[96:111], a[100:103], a[68:71], v[96:111]
    v_mfma_f32_32x32x16_bf16 v[96:111], a[104:107], a[72:75], v[96:111]
    v_mfma_f32_32x32x16_bf16 v[96:111], a[108:111], a[76:79], v[96:111]
    v_mfma_f32_32x32x16_bf16 v[96:111], a[112:115], a[80:83], v[96:111]
    buffer_load_dwordx4 v[88:91], v41, s[68:71], s96 offen offset:0 sc1
    buffer_load_dwordx4 v[92:95], v41, s[68:71], s96 offen offset:1024 sc1
    v_mfma_f32_32x32x16_bf16 v[96:111], a[116:119], a[84:87], v[96:111]
    s_waitcnt lgkmcnt(0)
    v_mfma_f32_32x32x16_bf16 v[96:111], a[120:123], a[88:91], v[96:111]
    v_mfma_f32_32x32x16_bf16 v[96:111], a[124:127], a[92:95], v[96:111]
    .p2align 3
    s_waitcnt vmcnt(9)
    v_xor_b32 v64, v161, v64
    v_xor_b32 v65, v162, v65
    v_xor_b32 v66, v163, v66
    v_xor_b32 v67, v180, v67
    s_waitcnt vmcnt(8)
    v_xor_b32 v68, v161, v68
    v_xor_b32 v69, v162, v69
    v_xor_b32 v70, v163, v70
    v_xor_b32 v71, v180, v71
    v_or3_b32 v63, v64, v65, v66
    v_or3_b32 v62, v67, v68, v69
    v_or3_b32 v63, v63, v70, v71
    v_or_b32 v63, v63, v62
    v_and_b32 v63, 0x10001, v63
    v_cmp_ne_u32 vcc, 0, v63
    s_cbranch_vccnz L_rp0
L_rp0_back:
    v_dot2c_f32_bf16 v192, s92, v64
    v_dot2c_f32_bf16 v194, s92, v65
    v_dot2c_f32_bf16 v196, s92, v66
    v_dot2c_f32_bf16 v198, s92, v67
    v_dot2c_f32_bf16 v200, s92, v68
    v_dot2c_f32_bf16 v202, s92, v69
    v_dot2c_f32_bf16 v204, s92, v70
    v_dot2c_f32_bf16 v206, s92, v71
    v_dot2c_f32_bf16 v193, s93, v64
    v_dot2c_f32_bf16 v195, s93, v65
    v_dot2c_f32_bf16 v197, s93, v66
    v_dot2c_f32_bf16 v199, s93, v67
    v_dot2c_f32_bf16 v201, s93, v68
    v_dot2c_f32_bf16 v203, s93, v69
    v_dot2c_f32_bf16 v205, s93, v70
    v_dot2c_f32_bf16 v207, s93, v71
    buffer_load_dwordx4 v[208:211], v41, s[68:71], s97 offen offset:0 sc1
    buffer_load_dwordx4 v[212:215], v41, s[68:71], s97 offen offset:1024 sc1
    s_waitcnt vmcnt(9)
    v_xor_b32 v72, v161, v72
    v_xor_b32 v73, v162, v73
    v_xor_b32 v74, v163, v74
    v_xor_b32 v75, v180, v75
    s_waitcnt vmcnt(8)
    v_xor_b32 v76, v161, v76
    v_xor_b32 v77, v162, v77
    v_xor_b32 v78, v163, v78
    v_xor_b32 v79, v180, v79
    v_or3_b32 v63, v72, v73, v74
    v_or3_b32 v62, v75, v76, v77
    v_or3_b32 v63, v63, v78, v79
    v_or_b32 v63, v63, v62
    v_and_b32 v63, 0x10001, v63
    v_cmp_ne_u32 vcc, 0, v63
    s_cbranch_vccnz L_rp1
L_rp1_back:
    v_dot2c_f32_bf16 v192, s92, v72
    v_dot2c_f32_bf16 v194, s92, v73
    v_dot2c_f32_bf16 v196, s92, v74
    v_dot2c_f32_bf16 v198, s92, v75
    v_dot2c_f32_bf16 v200, s92, v76
    v_dot2c_f32_bf16 v202, s92, v77
    v_dot2c_f32_bf16 v204, s92, v78
    v_dot2c_f32_bf16 v206, s92, v79
    v_dot2c_f32_bf16 v193, s93, v72
    v_dot2c_f32_bf16 v195, s93, v73
    v_dot2c_f32_bf16 v197, s93, v74
    v_dot2c_f32_bf16 v199, s93, v75
    v_dot2c_f32_bf16 v201, s93, v76
    v_dot2c_f32_bf16 v203, s93, v77
    v_dot2c_f32_bf16 v205, s93, v78
    v_dot2c_f32_bf16 v207, s93, v79
    s_waitcnt vmcnt(5)
    v_xor_b32 v80, v161, v80
    v_xor_b32 v81, v162, v81
    v_xor_b32 v82, v163, v82
    v_xor_b32 v83, v180, v83
    s_waitcnt vmcnt(4)
    v_xor_b32 v84, v161, v84
    v_xor_b32 v85, v162, v85
    v_xor_b32 v86, v163, v86
    v_xor_b32 v87, v180, v87
    v_or3_b32 v63, v80, v81, v82
    v_or3_b32 v62, v83, v84, v85
    v_or3_b32 v63, v63, v86, v87
    v_or_b32 v63, v63, v62
    v_and_b32 v63, 0x10001, v63
    v_cmp_ne_u32 vcc, 0, v63
    s_cbranch_vccnz L_rp2
L_rp2_back:
    v_dot2c_f32_bf16 v192, s92, v80
    v_dot2c_f32_bf16 v194, s92, v81
    v_dot2c_f32_bf16 v196, s92, v82
    v_dot2c_f32_bf16 v198, s92, v83
    v_dot2c_f32_bf16 v200, s92, v84
    v_dot2c_f32_bf16 v202, s92, v85
    v_dot2c_f32_bf16 v204, s92, v86
    v_dot2c_f32_bf16 v206, s92, v87
    v_dot2c_f32_bf16 v193, s93, v80
    v_dot2c_f32_bf16 v195, s93, v81
    v_dot2c_f32_bf16 v197, s93, v82
    v_dot2c_f32_bf16 v199, s93, v83
    v_dot2c_f32_bf16 v201, s93, v84
    v_dot2c_f32_bf16 v203, s93, v85
    v_dot2c_f32_bf16 v205, s93, v86
    v_dot2c_f32_bf16 v207, s93, v87
    s_waitcnt vmcnt(3)
    v_xor_b32 v88, v161, v88
    v_xor_b32 v89, v162, v89
    v_xor_b32 v90, v163, v90
    v_xor_b32 v91, v180, v91
    s_waitcnt vmcnt(2)
    v_xor_b32 v92, v161, v92
    v_xor_b32 v93, v162, v93
    v_xor_b32 v94, v163, v94
    v_xor_b32 v95, v180, v95
    v_or3_b32 v63, v88, v89, v90
    v_or3_b32 v62, v91, v92, v93
    v_or3_b32 v63, v63, v94, v95
    v_or_b32 v63, v63, v62
    v_and_b32 v63, 0x10001, v63
    v_cmp_ne_u32 vcc, 0, v63
    s_cbranch_vccnz L_rp3
L_rp3_back:
    v_dot2c_f32_bf16 v192, s92, v88
    v_dot2c_f32_bf16 v194, s92, v89
    v_dot2c_f32_bf16 v196, s92, v90
    v_dot2c_f32_bf16 v198, s92, v91
    v_dot2c_f32_bf16 v200, s92, v92
    v_dot2c_f32_bf16 v202, s92, v93
    v_dot2c_f32_bf16 v204, s92, v94
    v_dot2c_f32_bf16 v206, s92, v95
    v_dot2c_f32_bf16 v193, s93, v88
    v_dot2c_f32_bf16 v195, s93, v89
    v_dot2c_f32_bf16 v197, s93, v90
    v_dot2c_f32_bf16 v199, s93, v91
    v_dot2c_f32_bf16 v201, s93, v92
    v_dot2c_f32_bf16 v203, s93, v93
    v_dot2c_f32_bf16 v205, s93, v94
    v_dot2c_f32_bf16 v207, s93, v95
    buffer_load_dwordx4 v[216:219], v41, s[68:71], s22 offen offset:0 sc1
    buffer_load_dwordx4 v[220:223], v41, s[68:71], s22 offen offset:1024 sc1
    v_pk_add_f32 v[192:193], v[192:193], v[96:97]
    v_pk_add_f32 v[194:195], v[194:195], v[98:99]
    v_pk_add_f32 v[196:197], v[196:197], v[100:101]
    v_pk_add_f32 v[198:199], v[198:199], v[102:103]
    v_pk_add_f32 v[200:201], v[200:201], v[104:105]
    v_pk_add_f32 v[202:203], v[202:203], v[106:107]
    v_pk_add_f32 v[204:205], v[204:205], v[108:109]
    v_pk_add_f32 v[206:207], v[206:207], v[110:111]
    s_waitcnt vmcnt(3)
    v_xor_b32 v208, v161, v208
    v_xor_b32 v209, v162, v209
    v_xor_b32 v210, v163, v210
    v_xor_b32 v211, v180, v211
    s_waitcnt vmcnt(2)
    v_xor_b32 v212, v161, v212
    v_xor_b32 v213, v162, v213
    v_xor_b32 v214, v163, v214
    v_xor_b32 v215, v180, v215
    v_or3_b32 v63, v208, v209, v210
    v_or3_b32 v62, v211, v212, v213
    v_or3_b32 v63, v63, v214, v215
    v_or_b32 v63, v63, v62
    v_and_b32 v63, 0x10001, v63
    v_cmp_ne_u32 vcc, 0, v63
    s_cbranch_vccnz L_rp4
L_rp4_back:
    v_dot2c_f32_bf16 v192, s92, v208
    v_dot2c_f32_bf16 v194, s92, v209
    v_dot2c_f32_bf16 v196, s92, v210
    v_dot2c_f32_bf16 v198, s92, v211
    v_dot2c_f32_bf16 v200, s92, v212
    v_dot2c_f32_bf16 v202, s92, v213
    v_dot2c_f32_bf16 v204, s92, v214
    v_dot2c_f32_bf16 v206, s92, v215
    v_dot2c_f32_bf16 v193, s93, v208
    v_dot2c_f32_bf16 v195, s93, v209
    v_dot2c_f32_bf16 v197, s93, v210
    v_dot2c_f32_bf16 v199, s93, v211
    v_dot2c_f32_bf16 v201, s93, v212
    v_dot2c_f32_bf16 v203, s93, v213
    v_dot2c_f32_bf16 v205, s93, v214
    v_dot2c_f32_bf16 v207, s93, v215
    s_waitcnt vmcnt(1)
    v_xor_b32 v216, v161, v216
    v_xor_b32 v217, v162, v217
    v_xor_b32 v218, v163, v218
    v_xor_b32 v219, v180, v219
    s_waitcnt vmcnt(0)
    v_xor_b32 v220, v161, v220
    v_xor_b32 v221, v162, v221
    v_xor_b32 v222, v163, v222
    v_xor_b32 v223, v180, v223
    v_or3_b32 v63, v216, v217, v218
    v_or3_b32 v62, v219, v220, v221
    v_or3_b32 v63, v63, v222, v223
    v_or_b32 v63, v63, v62
    v_and_b32 v63, 0x10001, v63
    v_cmp_ne_u32 vcc, 0, v63
    s_cbranch_vccnz L_rp5
L_rp5_back:
    v_dot2c_f32_bf16 v192, s92, v216
    v_dot2c_f32_bf16 v194, s92, v217
    v_dot2c_f32_bf16 v196, s92, v218
    v_dot2c_f32_bf16 v198, s92, v219
    v_dot2c_f32_bf16 v200, s92, v220
    v_dot2c_f32_bf16 v202, s92, v221
    v_dot2c_f32_bf16 v204, s92, v222
    v_dot2c_f32_bf16 v206, s92, v223
    v_dot2c_f32_bf16 v193, s93, v216
    v_dot2c_f32_bf16 v195, s93, v217
    v_dot2c_f32_bf16 v197, s93, v218
    v_dot2c_f32_bf16 v199, s93, v219
    v_dot2c_f32_bf16 v201, s93, v220
    v_dot2c_f32_bf16 v203, s93, v221
    v_dot2c_f32_bf16 v205, s93, v222
    v_dot2c_f32_bf16 v207, s93, v223
    ds_write_b128 v253, v[192:195]
    v_xor_b32 v60, 16, v253
    ds_write_b128 v60, v[196:199]
    v_xor_b32 v61, 32, v253
    ds_write_b128 v61, v[200:203]
    v_xor_b32 v62, 48, v253
    ds_write_b128 v62, v[204:207]
    v_xor_b32 v59, 64, v0
    s_waitcnt lgkmcnt(0)
    ds_read_b128 v[96:99], v0 offset:0
    ds_read_b128 v[100:103], v0 offset:1024
    ds_read_b128 v[104:107], v59 offset:2048
    ds_read_b128 v[108:111], v59 offset:3072
    s_waitcnt lgkmcnt(3)
    buffer_store_dwordx4 v[96:99], v49, s[72:75], 0 offen nt
    s_mov_b32 s83, 14336
    s_waitcnt lgkmcnt(2)
    buffer_store_dwordx4 v[100:103], v49, s[72:75], s83 offen nt
    s_mov_b32 s83, 28672
    s_waitcnt lgkmcnt(1)
    buffer_store_dwordx4 v[104:107], v49, s[72:75], s83 offen nt
    s_mov_b32 s83, 43008
    s_waitcnt lgkmcnt(0)
    buffer_store_dwordx4 v[108:111], v49, s[72:75], s83 offen nt
    s_sub_u32 s83, s78, 31
    s_or_b32 s83, s83, s77
    s_or_b32 s83, s83, s76
    s_cbranch_scc1 L_fin
    v_mov_b32 v59, s90
    v_mov_b32 v60, 0
    s_mov_b64 exec, 1
    global_store_dword v60, v59, s[36:37] sc1
    s_mov_b64 exec, -1
L_fin:
L_exit:
    s_endpgm
L_rs:
    s_cmp_eq_u32 s94, 0
    s_cbranch_scc1 L_rs_back
    s_sub_u32 s94, s94, 1
    s_mov_b32 s89, m0
    s_mov_b32 m0, s34
    s_nop 0
    buffer_load_dwordx4 v42, s[64:67], 0 offen offset:0 sc1 lds
    buffer_load_dwordx4 v42, s[64:67], 0 offen offset:1024 sc1 lds
    buffer_load_dwordx4 v42, s[64:67], 0 offen offset:2048 sc1 lds
    buffer_load_dwordx4 v42, s[64:67], 0 offen offset:3072 sc1 lds
    s_waitcnt vmcnt(0)
    ds_read2st64_b32 v[192:193], v43 offset0:0 offset1:1
    ds_read2st64_b32 v[194:195], v43 offset0:2 offset1:3
    ds_read2st64_b32 v[196:197], v43 offset0:4 offset1:5
    ds_read2st64_b32 v[198:199], v43 offset0:6 offset1:7
    ds_read2st64_b32 v[200:201], v43 offset0:8 offset1:9
    ds_read2st64_b32 v[202:203], v43 offset0:10 offset1:11
    ds_read2st64_b32 v[204:205], v43 offset0:12 offset1:13
    ds_read2st64_b32 v[206:207], v43 offset0:14 offset1:15
    s_waitcnt lgkmcnt(6)
    v_add_u32_sdwa v59, v192, v194 dst_sel:DWORD dst_unused:UNUSED_PAD src0_sel:BYTE_0 src1_sel:BYTE_0
    v_add_u32_sdwa v60, v193, v195 dst_sel:DWORD dst_unused:UNUSED_PAD src0_sel:BYTE_0 src1_sel:BYTE_0
    s_waitcnt lgkmcnt(5)
    v_add_u32_sdwa v59, v59, v196 dst_sel:DWORD dst_unused:UNUSED_PAD src0_sel:DWORD src1_sel:BYTE_0
    v_add_u32_sdwa v60, v60, v197 dst_sel:DWORD dst_unused:UNUSED_PAD src0_sel:DWORD src1_sel:BYTE_0
    s_waitcnt lgkmcnt(4)
    v_add_u32_sdwa v59, v59, v198 dst_sel:DWORD dst_unused:UNUSED_PAD src0_sel:DWORD src1_sel:BYTE_0
    v_add_u32_sdwa v60, v60, v199 dst_sel:DWORD dst_unused:UNUSED_PAD src0_sel:DWORD src1_sel:BYTE_0
    s_waitcnt lgkmcnt(3)
    v_add_u32_sdwa v59, v59, v200 dst_sel:DWORD dst_unused:UNUSED_PAD src0_sel:DWORD src1_sel:BYTE_0
    v_add_u32_sdwa v60, v60, v201 dst_sel:DWORD dst_unused:UNUSED_PAD src0_sel:DWORD src1_sel:BYTE_0
    s_waitcnt lgkmcnt(2)
    v_add_u32_sdwa v59, v59, v202 dst_sel:DWORD dst_unused:UNUSED_PAD src0_sel:DWORD src1_sel:BYTE_0
    v_add_u32_sdwa v60, v60, v203 dst_sel:DWORD dst_unused:UNUSED_PAD src0_sel:DWORD src1_sel:BYTE_0
    s_waitcnt lgkmcnt(1)
    v_add_u32_sdwa v59, v59, v204 dst_sel:DWORD dst_unused:UNUSED_PAD src0_sel:DWORD src1_sel:BYTE_0
    v_add_u32_sdwa v60, v60, v205 dst_sel:DWORD dst_unused:UNUSED_PAD src0_sel:DWORD src1_sel:BYTE_0
    s_waitcnt lgkmcnt(0)
    v_add_u32_sdwa v59, v59, v206 dst_sel:DWORD dst_unused:UNUSED_PAD src0_sel:DWORD src1_sel:BYTE_0
    v_add_u32_sdwa v60, v60, v207 dst_sel:DWORD dst_unused:UNUSED_PAD src0_sel:DWORD src1_sel:BYTE_0
    v_add_u32 v59, v59, v60
    v_cmp_ne_u32 vcc, v59, v58
    s_mov_b32 m0, s89
    s_cbranch_vccnz L_rs
    s_branch L_rs_back
L_rp0:
    s_cmp_eq_u32 s94, 0
    s_cbranch_scc1 L_rp0_back
    s_sub_u32 s94, s94, 1
    buffer_load_dwordx4 v[64:67], v41, s[68:71], s3 offen offset:0 sc1
    buffer_load_dwordx4 v[68:71], v41, s[68:71], s3 offen offset:1024 sc1
    s_waitcnt vmcnt(1)
    v_xor_b32 v64, v161, v64
    v_xor_b32 v65, v162, v65
    v_xor_b32 v66, v163, v66
    v_xor_b32 v67, v180, v67
    s_waitcnt vmcnt(0)
    v_xor_b32 v68, v161, v68
    v_xor_b32 v69, v162, v69
    v_xor_b32 v70, v163, v70
    v_xor_b32 v71, v180, v71
    v_or3_b32 v63, v64, v65, v66
    v_or3_b32 v62, v67, v68, v69
    v_or3_b32 v63, v63, v70, v71
    v_or_b32 v63, v63, v62
    v_and_b32 v63, 0x10001, v63
    v_cmp_ne_u32 vcc, 0, v63
    s_cbranch_vccnz L_rp0
    s_branch L_rp0_back
L_rp1:
    s_cmp_eq_u32 s94, 0
    s_cbranch_scc1 L_rp1_back
    s_sub_u32 s94, s94, 1
    buffer_load_dwordx4 v[72:75], v41, s[68:71], s38 offen offset:0 sc1
    buffer_load_dwordx4 v[76:79], v41, s[68:71], s38 offen offset:1024 sc1
    s_waitcnt vmcnt(1)
    v_xor_b32 v72, v161, v72
    v_xor_b32 v73, v162, v73
    v_xor_b32 v74, v163, v74
    v_xor_b32 v75, v180, v75
    s_waitcnt vmcnt(0)
    v_xor_b32 v76, v161, v76
    v_xor_b32 v77, v162, v77
    v_xor_b32 v78, v163, v78
    v_xor_b32 v79, v180, v79
    v_or3_b32 v63, v72, v73, v74
    v_or3_b32 v62, v75, v76, v77
    v_or3_b32 v63, v63, v78, v79
    v_or_b32 v63, v63, v62
    v_and_b32 v63, 0x10001, v63
    v_cmp_ne_u32 vcc, 0, v63
    s_cbranch_vccnz L_rp1
    s_branch L_rp1_back
L_rp2:
    s_cmp_eq_u32 s94, 0
    s_cbranch_scc1 L_rp2_back
    s_sub_u32 s94, s94, 1
    buffer_load_dwordx4 v[80:83], v41, s[68:71], s39 offen offset:0 sc1
    buffer_load_dwordx4 v[84:87], v41, s[68:71], s39 offen offset:1024 sc1
    s_waitcnt vmcnt(1)
    v_xor_b32 v80, v161, v80
    v_xor_b32 v81, v162, v81
    v_xor_b32 v82, v163, v82
    v_xor_b32 v83, v180, v83
    s_waitcnt vmcnt(0)
    v_xor_b32 v84, v161, v84
    v_xor_b32 v85, v162, v85
    v_xor_b32 v86, v163, v86
    v_xor_b32 v87, v180, v87
    v_or3_b32 v63, v80, v81, v82
    v_or3_b32 v62, v83, v84, v85
    v_or3_b32 v63, v63, v86, v87
    v_or_b32 v63, v63, v62
    v_and_b32 v63, 0x10001, v63
    v_cmp_ne_u32 vcc, 0, v63
    s_cbranch_vccnz L_rp2
    s_branch L_rp2_back
L_rp3:
    s_cmp_eq_u32 s94, 0
    s_cbranch_scc1 L_rp3_back
    s_sub_u32 s94, s94, 1
    buffer_load_dwordx4 v[88:91], v41, s[68:71], s96 offen offset:0 sc1
    buffer_load_dwordx4 v[92:95], v41, s[68:71], s96 offen offset:1024 sc1
    s_waitcnt vmcnt(1)
    v_xor_b32 v88, v161, v88
    v_xor_b32 v89, v162, v89
    v_xor_b32 v90, v163, v90
    v_xor_b32 v91, v180, v91
    s_waitcnt vmcnt(0)
    v_xor_b32 v92, v161, v92
    v_xor_b32 v93, v162, v93
    v_xor_b32 v94, v163, v94
    v_xor_b32 v95, v180, v95
    v_or3_b32 v63, v88, v89, v90
    v_or3_b32 v62, v91, v92, v93
    v_or3_b32 v63, v63, v94, v95
    v_or_b32 v63, v63, v62
    v_and_b32 v63, 0x10001, v63
    v_cmp_ne_u32 vcc, 0, v63
    s_cbranch_vccnz L_rp3
    s_branch L_rp3_back
L_rp4:
    s_cmp_eq_u32 s94, 0
    s_cbranch_scc1 L_rp4_back
    s_sub_u32 s94, s94, 1
    buffer_load_dwordx4 v[208:211], v41, s[68:71], s97 offen offset:0 sc1
    buffer_load_dwordx4 v[212:215], v41, s[68:71], s97 offen offset:1024 sc1
    s_waitcnt vmcnt(1)
    v_xor_b32 v208, v161, v208
    v_xor_b32 v209, v162, v209
    v_xor_b32 v210, v163, v210
    v_xor_b32 v211, v180, v211
    s_waitcnt vmcnt(0)
    v_xor_b32 v212, v161, v212
    v_xor_b32 v213, v162, v213
    v_xor_b32 v214, v163, v214
    v_xor_b32 v215, v180, v215
    v_or3_b32 v63, v208, v209, v210
    v_or3_b32 v62, v211, v212, v213
    v_or3_b32 v63, v63, v214, v215
    v_or_b32 v63, v63, v62
    v_and_b32 v63, 0x10001, v63
    v_cmp_ne_u32 vcc, 0, v63
    s_cbranch_vccnz L_rp4
    s_branch L_rp4_back
L_rp5:
    s_cmp_eq_u32 s94, 0
    s_cbranch_scc1 L_rp5_back
    s_sub_u32 s94, s94, 1
    buffer_load_dwordx4 v[216:219], v41, s[68:71], s22 offen offset:0 sc1
    buffer_load_dwordx4 v[220:223], v41, s[68:71], s22 offen offset:1024 sc1
    s_waitcnt vmcnt(1)
    v_xor_b32 v216, v161, v216
    v_xor_b32 v217, v162, v217
    v_xor_b32 v218, v163, v218
    v_xor_b32 v219, v180, v219
    s_waitcnt vmcnt(0)
    v_xor_b32 v220, v161, v220
    v_xor_b32 v221, v162, v221
    v_xor_b32 v222, v163, v222
    v_xor_b32 v223, v180, v223
    v_or3_b32 v63, v216, v217, v218
    v_or3_b32 v62, v219, v220, v221
    v_or3_b32 v63, v63, v222, v223
    v_or_b32 v63, v63, v62
    v_and_b32 v63, 0x10001, v63
    v_cmp_ne_u32 vcc, 0, v63
    s_cbranch_vccnz L_rp5
    s_branch L_rp5_back
L_helper:
    s_and_b32 s83, s83, 3
    s_lshl_b32 s83, s83, 2
    s_add_u32 s83, s83, s76
    s_mul_i32 s84, s84, 3
    v_lshl_add_u32 v2, s83, 6, v1
    s_waitcnt lgkmcnt(0)
    v_lshrrev_b32 v4, 4, v2
    v_and_b32 v5, 15, v2
    v_mul_u32_u24 v4, 3584, v4
    v_lshl_add_u32 v4, v5, 7, v4
    s_lshl_b32 s89, s84, 9
    v_add_u32 v4, s89, v4
    global_load_dword v10, v4, s[24:25]
    v_add_u32 v4, 229376, v4
    global_load_dword v11, v4, s[24:25]
    v_add_u32 v4, 229376, v4
    global_load_dword v12, v4, s[24:25]
    v_add_u32 v4, 229376, v4
    global_load_dword v13, v4, s[24:25]
    v_add_u32 v4, 229376, v4
    global_load_dword v14, v4, s[24:25]
    v_add_u32 v4, 229376, v4
    global_load_dword v15, v4, s[24:25]
    v_add_u32 v4, 229376, v4
    global_load_dword v16, v4, s[24:25]
    v_lshrrev_b32 v6, 2, v2
    v_and_b32 v5, 3, v2
    v_lshlrev_b32 v5, 7, v5
    s_lshl_b32 s89, s84, 7
    v_add_u32 v5, s89, v5
    v_add_u32 v7, 256, v6
    v_min_u32 v7, 447, v7
    v_mul_u32_u24 v6, 896, v6
    v_mul_u32_u24 v7, 896, v7
    v_add_u32 v6, v6, v5
    v_add_u32 v7, v7, v5
    s_mul_i32 s89, s84, 229376
    v_lshlrev_b32 v8, 7, v2
    v_add_u32 v8, s89, v8
    global_load_dword v17, v6, s[14:15]
    global_load_dword v18, v6, s[16:17]
    global_load_dword v19, v7, s[14:15]
    global_load_dword v20, v7, s[16:17]
    global_load_dword v21, v8, s[28:29]
    v_add_u32 v8, 131072, v8
    global_load_dword v22, v8, s[28:29]
    v_add_u32 v8, 131072, v8
    global_load_dword v23, v8, s[28:29]
    v_add_u32 v8, 131072, v8
    global_load_dword v24, v8, s[28:29]
    v_add_u32 v8, 131072, v8
    global_load_dword v25, v8, s[28:29]
    v_add_u32 v8, 131072, v8
    global_load_dword v26, v8, s[28:29]
    v_add_u32 v8, 131072, v8
    global_load_dword v27, v8, s[28:29]
    s_waitcnt vmcnt(0)
    s_endpgm
L_end:
.section .rodata,"a"
.p2align 6
.amdhsa_kernel gated_mix__ssm_conv_s5__dense_activation_gelu__prompt_kernel
  .amdhsa_next_free_vgpr 512
  .amdhsa_next_free_sgpr 102
  .amdhsa_accum_offset 256
  .amdhsa_group_segment_fixed_size 0
  .amdhsa_kernarg_size 144
  .amdhsa_user_sgpr_count 2
  .amdhsa_user_sgpr_kernarg_segment_ptr 1
  .amdhsa_system_sgpr_workgroup_id_x 1
.end_amdhsa_kernel
```
